```python
import torch

def _softmax(x, axis=-1):
    return torch.softmax(x, dim=axis)
def _gelu(x):
    return torch.nn.functional.gelu(x, approximate="tanh")
def _silu(x):
    return torch.nn.functional.silu(x)
def _sigmoid(x):
    return torch.sigmoid(x)
def _layernorm(x, axis=-1, eps=1e-5):
    m = x.mean(dim=axis, keepdim=True)
    v = x.var(dim=axis, keepdim=True, unbiased=False)
    return (x - m) / torch.sqrt(v + eps)
def _scatter_add(tgt, idx, src, axis=0):
    return tgt.clone().index_add_(axis, idx, src)
def _segment_sum(src, seg, n):
    out = torch.zeros((n,) + src.shape[1:], dtype=src.dtype)
    return out.index_add_(0, seg, src)
def _pad(x, pw):
    flat = tuple(v for pair in reversed(pw) for v in pair)
    return torch.nn.functional.pad(x, flat)

kernel_name = 'parallel_sum__mha_block_cached__geglu_ffn__decode'

def setup_inputs():

    _w = (lambda a: (lambda t: t.to(torch.bfloat16) if t.is_floating_point() else t)(torch.as_tensor(a)))
    def _A_setup():
        B, Sq, D = 4, 1, 576
        H, Sk, Dh = 32, 8192, 128
        return {
            "x": _w((lambda *s: torch.randn(*s, dtype=torch.bfloat16) * 0.05)(B, Sq, D)),
            "k_cache": _w((lambda *s: torch.randn(*s, dtype=torch.bfloat16) * 3.2)(B, H, Sk, Dh)),
            "v_cache": _w((lambda *s: torch.randn(*s, dtype=torch.bfloat16) * 1.6)(B, H, Sk, Dh)),
            "wq": _w((lambda *s: torch.randn(*s, dtype=torch.bfloat16) * 3.2)(D, H * Dh) * (D ** -0.5)),
            "wo": _w((lambda *s: torch.randn(*s, dtype=torch.bfloat16) * 1.6)(H * Dh, D) * ((H * Dh) ** -0.5)),
        }
    _A_in = _A_setup()

    def _B_setup():
        B, S, D, F = 4, 1, 576, 4608
        return {
            "x": _w((lambda *s: torch.randn(*s, dtype=torch.bfloat16) * 0.05)(B, S, D)),
            "w_gate": _w((lambda *s: torch.randn(*s, dtype=torch.bfloat16) * 0.05)(D, F)),
            "w_up": _w((lambda *s: torch.randn(*s, dtype=torch.bfloat16) * 0.05)(D, F)),
            "w_down": _w((lambda *s: torch.randn(*s, dtype=torch.bfloat16) * 0.05)(F, D)),
        }
    _B_in = _B_setup()

    return {
        "A_x": _A_in["x"],
        "A_k_cache": _A_in["k_cache"],
        "A_v_cache": _A_in["v_cache"],
        "A_wq": _A_in["wq"],
        "A_wo": _A_in["wo"],
        "B_x": _B_in["x"],
        "B_w_gate": _B_in["w_gate"],
        "B_w_up": _B_in["w_up"],
        "B_w_down": _B_in["w_down"],
    }

def reference(A_x, A_k_cache, A_v_cache, A_wq, A_wo, B_x, B_w_gate, B_w_up, B_w_down):
    def _A_ref(x, k_cache, v_cache, wq, wo):
        B, Sq, D = x.shape
        H, Dh = 32, 128
        q = (lambda x, *d: x.permute(*d))((x @ wq).reshape(B, Sq, H, Dh), 0, 2, 1, 3)
        scores = torch.einsum("bhqd,bhkd->bhqk", q, k_cache) * (Dh ** -0.5)
        p = _softmax(scores, axis=-1)
        o = torch.einsum("bhqk,bhkd->bhqd", p, v_cache)
        return (lambda x, *d: x.permute(*d))(o, 0, 2, 1, 3).reshape(B, Sq, H * Dh) @ wo

    def _B_ref(x, w_gate, w_up, w_down):
        return (_gelu(x @ w_gate) * (x @ w_up)) @ w_down

    x = A_x
    xn = _layernorm(x, axis=-1)
    return x + _A_ref(xn, A_k_cache, A_v_cache, A_wq, A_wo) + _B_ref(xn, B_w_gate, B_w_up, B_w_down)
```

```asm
; @launch grid=(256,1,1) block=(512,1,1) lds=129024
.amdgcn_target "amdgcn-amd-amdhsa--gfx950"
.text
.globl parallel_sum__mha_block_cached__geglu_ffn__decode_kernel
.p2align 8
.type parallel_sum__mha_block_cached__geglu_ffn__decode_kernel,@function
parallel_sum__mha_block_cached__geglu_ffn__decode_kernel:
    s_cmp_ge_u32 s2, 256
    s_cbranch_scc1 L_end
    s_load_dwordx16 s[4:19], s[0:1], 0
    s_load_dwordx8 s[20:27], s[0:1], 64
    v_lshrrev_b32 v1, 6, v0
    v_and_b32 v0, 63, v0
    v_readfirstlane_b32 s3, v1
    s_and_b32 s48, s2, 7
    s_lshr_b32 s49, s2, 3
    s_bfe_u32 s52, s49, 0x20001
    s_lshl_b32 s53, s48, 2
    s_add_u32 s52, s52, s53
    s_lshr_b32 s53, s49, 3
    s_lshl_b32 s53, s53, 1
    s_add_u32 s96, s48, s53
    s_and_b32 s96, s96, 7
    s_and_b32 s78, s49, 1
    s_add_u32 s53, s53, s78
    s_lshl_b32 s79, 1, s96
    s_and_b32 s79, s79, 0x90
    s_cselect_b32 s98, 1, 0
    s_andn2_b32 s98, s98, s78
    v_lshlrev_b32 v1, 4, v0
    s_mov_b32 s85, 1069066811
    v_mov_b32 v8, 7936
    v_mov_b32 v10, 0
    v_mov_b32 v11, 0
    v_mov_b32 v12, 0
    v_mov_b32 v13, 0
    s_cmp_lg_u32 s3, 0
    s_cbranch_scc1 L_b0
    ds_write_b128 v8, v[10:13]
    ds_write_b128 v8, v[10:13] offset:16
L_b0:
    s_waitcnt lgkmcnt(0)
    s_mov_b32 s94, 6291456
    s_load_dword s94, s[26:27], s94
    s_mov_b32 s44, s26
    s_mov_b32 s45, s27
    s_mov_b32 s46, 6291584
    s_mov_b32 s47, 0x20000
    s_cmp_ge_u32 s3, 4
    s_cbranch_scc0 L_stream
L_svc:
    s_setprio 3
    s_sub_u32 s56, s3, 4
    s_mul_i32 s57, s56, 9
    s_lshr_b32 s57, s57, 1
    v_lshrrev_b32 v8, 3, v0
    v_and_b32 v10, 7, v0
    v_lshlrev_b32 v10, 4, v10
    v_mul_u32_u24 v31, 1152, v8
    v_add_u32 v31, v31, v10
    s_mov_b32 s58, 0
    s_mov_b32 s59, -1
    s_sub_u32 s78, s96, 5
    s_cmp_lt_u32 s78, 2
    s_cbranch_scc1 L_tq
    s_and_b32 s78, s49, 1
    s_add_u32 s78, s78, 4
    s_cmp_ge_u32 s96, s78
    s_cbranch_scc1 L_notask
    s_mul_i32 s80, s49, 9
    s_lshr_b32 s80, s80, 1
    s_add_u32 s80, s80, s96
    s_lshl_b32 s51, s80, 10
    s_add_u32 s51, s51, 1572864
    s_cmp_ge_u32 s80, 72
    s_cselect_b32 s40, s18, s16
    s_cselect_b32 s41, s19, s17
    s_cselect_b32 s78, 72, 0
    s_mov_b32 s42, 5308416
    s_sub_u32 s80, s80, s78
    s_movk_i32 s50, 9216
    s_branch L_task
L_tq:
    s_lshl_b32 s80, s49, 1
    s_add_u32 s80, s80, s78
    s_lshl_b32 s51, s80, 10
    s_add_u32 s51, s51, 1048576
    s_mov_b32 s40, s10
    s_mov_b32 s41, s11
    s_mov_b32 s42, 4718592
    s_movk_i32 s50, 8192
L_task:
    s_mov_b32 s43, 0x20000
    s_mul_i32 s36, s56, 1152
    s_add_u32 s36, s4, s36
    s_addc_u32 s37, s5, 0
    s_mov_b32 s38, 1152
    s_mov_b32 s39, 0x20000
    v_lshlrev_b32 v7, 2, v0
    buffer_load_dword v2, v7, s[36:39], 0 offen offset:0
    buffer_load_dword v3, v7, s[36:39], 0 offen offset:256
    buffer_load_dword v4, v7, s[36:39], 0 offen offset:512
    buffer_load_dword v5, v7, s[36:39], 0 offen offset:768
    buffer_load_dword v6, v7, s[36:39], 0 offen offset:1024
    v_bfe_u32 v9, v0, 4, 1
    v_lshlrev_b32 v9, 5, v9
    v_xor_b32 v10, v10, v9
    v_mul_u32_u24 v8, s50, v8
    v_add_u32 v8, v8, v10
    v_xor_b32 v9, 64, v8
    s_lshl_b32 s78, s80, 7
    s_mul_i32 s79, s56, 144
    s_mul_i32 s79, s79, s50
    s_add_u32 s78, s78, s79
    s_lshl_b32 s82, s50, 3
    s_lshl_b32 s79, s56, 8
    s_add_u32 s51, s51, s79
    s_mul_i32 s79, s56, 18432
    s_add_u32 m0, s79, 12288
    s_nop 0
    buffer_load_dwordx4 v8, s[40:43], s78 offen nt lds
    s_add_u32 m0, s79, 13312
    s_add_u32 s78, s78, s82
    buffer_load_dwordx4 v9, s[40:43], s78 offen nt lds
    s_add_u32 m0, s79, 14336
    s_add_u32 s78, s78, s82
    buffer_load_dwordx4 v8, s[40:43], s78 offen nt lds
    s_add_u32 m0, s79, 15360
    s_add_u32 s78, s78, s82
    buffer_load_dwordx4 v9, s[40:43], s78 offen nt lds
    s_add_u32 m0, s79, 16384
    s_add_u32 s78, s78, s82
    buffer_load_dwordx4 v8, s[40:43], s78 offen nt lds
    s_add_u32 m0, s79, 17408
    s_add_u32 s78, s78, s82
    buffer_load_dwordx4 v9, s[40:43], s78 offen nt lds
    s_add_u32 m0, s79, 18432
    s_add_u32 s78, s78, s82
    buffer_load_dwordx4 v8, s[40:43], s78 offen nt lds
    s_add_u32 m0, s79, 19456
    s_add_u32 s78, s78, s82
    buffer_load_dwordx4 v9, s[40:43], s78 offen nt lds
    s_add_u32 m0, s79, 20480
    s_add_u32 s78, s78, s82
    buffer_load_dwordx4 v8, s[40:43], s78 offen nt lds
    s_add_u32 m0, s79, 21504
    s_add_u32 s78, s78, s82
    buffer_load_dwordx4 v9, s[40:43], s78 offen nt lds
    s_add_u32 m0, s79, 22528
    s_add_u32 s78, s78, s82
    buffer_load_dwordx4 v8, s[40:43], s78 offen nt lds
    s_add_u32 m0, s79, 23552
    s_add_u32 s78, s78, s82
    buffer_load_dwordx4 v9, s[40:43], s78 offen nt lds
    s_add_u32 m0, s79, 24576
    s_add_u32 s78, s78, s82
    buffer_load_dwordx4 v8, s[40:43], s78 offen nt lds
    s_add_u32 m0, s79, 25600
    s_add_u32 s78, s78, s82
    buffer_load_dwordx4 v9, s[40:43], s78 offen nt lds
    s_add_u32 m0, s79, 26624
    s_add_u32 s78, s78, s82
    buffer_load_dwordx4 v8, s[40:43], s78 offen nt lds
    s_add_u32 m0, s79, 27648
    s_add_u32 s78, s78, s82
    buffer_load_dwordx4 v9, s[40:43], s78 offen nt lds
    s_add_u32 m0, s79, 28672
    s_add_u32 s78, s78, s82
    buffer_load_dwordx4 v8, s[40:43], s78 offen nt lds
    s_add_u32 m0, s79, 29696
    s_add_u32 s78, s78, s82
    buffer_load_dwordx4 v9, s[40:43], s78 offen nt lds
    s_barrier
    s_waitcnt vmcnt(18)
    v_lshlrev_b32 v10, 16, v2
    v_and_b32 v11, 0xffff0000, v2
    v_lshlrev_b32 v12, 16, v3
    v_and_b32 v13, 0xffff0000, v3
    v_lshlrev_b32 v14, 16, v4
    v_and_b32 v15, 0xffff0000, v4
    v_lshlrev_b32 v16, 16, v5
    v_and_b32 v17, 0xffff0000, v5
    v_lshlrev_b32 v18, 16, v6
    v_and_b32 v19, 0xffff0000, v6
    v_add_f32 v20, v10, v11
    v_add_f32 v20, v20, v12
    v_add_f32 v20, v20, v13
    v_add_f32 v20, v20, v14
    v_add_f32 v20, v20, v15
    v_add_f32 v20, v20, v16
    v_add_f32 v20, v20, v17
    v_add_f32 v20, v20, v18
    v_add_f32 v20, v20, v19
    s_nop 1
    v_add_f32_dpp v20, v20, v20 row_ror:8 row_mask:0xf bank_mask:0xf
    s_nop 1
    v_add_f32_dpp v20, v20, v20 row_ror:4 row_mask:0xf bank_mask:0xf
    s_nop 1
    v_add_f32_dpp v20, v20, v20 row_ror:2 row_mask:0xf bank_mask:0xf
    s_nop 1
    v_add_f32_dpp v20, v20, v20 row_ror:1 row_mask:0xf bank_mask:0xf
    v_mov_b32 v21, v20
    s_nop 1
    v_permlane16_swap_b32 v20, v21
    s_nop 0
    v_add_f32 v20, v20, v21
    v_mov_b32 v21, v20
    s_nop 1
    v_permlane32_swap_b32 v20, v21
    s_nop 0
    v_add_f32 v20, v20, v21
    v_mul_f32 v20, 0x3ae38e39, v20
    v_cmp_gt_u32 vcc, 32, v0
    v_sub_f32 v22, v10, v20
    v_sub_f32 v23, v11, v20
    v_sub_f32 v24, v12, v20
    v_sub_f32 v25, v13, v20
    v_sub_f32 v26, v14, v20
    v_sub_f32 v27, v15, v20
    v_sub_f32 v28, v16, v20
    v_sub_f32 v29, v17, v20
    v_sub_f32 v2, v18, v20
    v_sub_f32 v3, v19, v20
    v_cndmask_b32 v2, 0, v2, vcc
    v_cndmask_b32 v3, 0, v3, vcc
    v_mul_f32 v21, v2, v2
    v_fmac_f32 v21, v3, v3
    v_fmac_f32 v21, v22, v22
    v_fmac_f32 v21, v23, v23
    v_fmac_f32 v21, v24, v24
    v_fmac_f32 v21, v25, v25
    v_fmac_f32 v21, v26, v26
    v_fmac_f32 v21, v27, v27
    v_fmac_f32 v21, v28, v28
    v_fmac_f32 v21, v29, v29
    s_nop 1
    v_add_f32_dpp v21, v21, v21 row_ror:8 row_mask:0xf bank_mask:0xf
    s_nop 1
    v_add_f32_dpp v21, v21, v21 row_ror:4 row_mask:0xf bank_mask:0xf
    s_nop 1
    v_add_f32_dpp v21, v21, v21 row_ror:2 row_mask:0xf bank_mask:0xf
    s_nop 1
    v_add_f32_dpp v21, v21, v21 row_ror:1 row_mask:0xf bank_mask:0xf
    v_mov_b32 v22, v21
    s_nop 1
    v_permlane16_swap_b32 v21, v22
    s_nop 0
    v_add_f32 v21, v21, v22
    v_mov_b32 v22, v21
    s_nop 1
    v_permlane32_swap_b32 v21, v22
    s_nop 0
    v_add_f32 v21, v21, v22
    v_mul_f32 v21, 0x3ae38e39, v21
    v_cvt_pk_bf16_f32 v21, v21, v21
    v_and_b32 v21, 0xffff0000, v21
    v_add_f32 v21, 0x3727c5ac, v21
    v_cvt_pk_bf16_f32 v21, v21, v21
    v_and_b32 v21, 0xffff0000, v21
    v_sqrt_f32 v21, v21
    s_nop 0
    v_cvt_pk_bf16_f32 v21, v21, v21
    v_and_b32 v21, 0xffff0000, v21
    v_rcp_f32 v21, v21
    v_cvt_pk_bf16_f32 v20, v20, v20
    v_and_b32 v20, 0xffff0000, v20
    v_sub_f32 v10, v10, v20
    v_sub_f32 v11, v11, v20
    v_sub_f32 v12, v12, v20
    v_sub_f32 v13, v13, v20
    v_sub_f32 v14, v14, v20
    v_sub_f32 v15, v15, v20
    v_sub_f32 v16, v16, v20
    v_sub_f32 v17, v17, v20
    v_sub_f32 v18, v18, v20
    v_sub_f32 v19, v19, v20
    v_cvt_pk_bf16_f32 v2, v10, v11
    v_cvt_pk_bf16_f32 v3, v12, v13
    v_cvt_pk_bf16_f32 v4, v14, v15
    v_cvt_pk_bf16_f32 v5, v16, v17
    v_cvt_pk_bf16_f32 v6, v18, v19
    v_lshlrev_b32 v10, 16, v2
    v_and_b32 v11, 0xffff0000, v2
    v_lshlrev_b32 v12, 16, v3
    v_and_b32 v13, 0xffff0000, v3
    v_lshlrev_b32 v14, 16, v4
    v_and_b32 v15, 0xffff0000, v4
    v_lshlrev_b32 v16, 16, v5
    v_and_b32 v17, 0xffff0000, v5
    v_lshlrev_b32 v18, 16, v6
    v_and_b32 v19, 0xffff0000, v6
    v_mul_f32 v10, v10, v21
    v_mul_f32 v11, v11, v21
    v_mul_f32 v12, v12, v21
    v_mul_f32 v13, v13, v21
    v_mul_f32 v14, v14, v21
    v_mul_f32 v15, v15, v21
    v_mul_f32 v16, v16, v21
    v_mul_f32 v17, v17, v21
    v_mul_f32 v18, v18, v21
    v_mul_f32 v19, v19, v21
    v_cvt_pk_bf16_f32 v2, v10, v11
    v_cvt_pk_bf16_f32 v3, v12, v13
    v_cvt_pk_bf16_f32 v4, v14, v15
    v_cvt_pk_bf16_f32 v5, v16, v17
    v_cvt_pk_bf16_f32 v6, v18, v19
    s_mul_i32 s78, s56, 1152
    v_add_u32 v7, s78, v7
    ds_write_b32 v7, v2 offset:0
    ds_write_b32 v7, v3 offset:256
    ds_write_b32 v7, v4 offset:512
    ds_write_b32 v7, v5 offset:768
    s_mov_b64 exec, 0xffffffff
    ds_write_b32 v7, v6 offset:1024
    s_mov_b64 exec, -1
    s_cmp_eq_u32 s50, 8192
    s_cbranch_scc1 L_qnp
    s_lshl_b32 s81, s53, 7
    s_mov_b32 s40, s12
    s_mov_b32 s41, s13
    s_mov_b32 s42, 4718592
    s_mov_b32 s43, 0x20000
    s_mul_i32 s78, s52, 147456
    s_add_u32 s78, s78, s81
    s_mul_i32 s79, s56, 36864
    s_add_u32 s78, s78, s79
    s_lshl_b32 s79, s56, 12
    s_add_u32 m0, s79, 86016
    s_nop 0
    buffer_load_dwordx4 v31, s[40:43], s78 offen nt lds
    s_add_u32 m0, s79, 87040
    s_add_u32 s78, s78, 9216
    buffer_load_dwordx4 v31, s[40:43], s78 offen nt lds
    s_add_u32 m0, s79, 88064
    s_add_u32 s78, s78, 9216
    buffer_load_dwordx4 v31, s[40:43], s78 offen nt lds
    s_add_u32 m0, s79, 89088
    s_add_u32 s78, s78, 9216
    buffer_load_dwordx4 v31, s[40:43], s78 offen nt lds
    s_mov_b32 s40, s20
    s_mov_b32 s41, s21
    s_mov_b32 s42, 5308416
    s_mov_b32 s43, 0x20000
    s_mul_i32 s78, s52, 165888
    s_add_u32 s78, s78, s81
    s_mul_i32 s79, s57, 9216
    s_add_u32 s78, s78, s79
    s_lshl_b32 s79, s57, 10
    s_add_u32 m0, s79, 102400
    s_nop 0
    buffer_load_dwordx4 v31, s[40:43], s78 offen nt lds
    s_add_u32 m0, s79, 103424
    s_add_u32 s78, s78, 9216
    buffer_load_dwordx4 v31, s[40:43], s78 offen nt lds
    s_add_u32 m0, s79, 104448
    s_add_u32 s78, s78, 9216
    buffer_load_dwordx4 v31, s[40:43], s78 offen nt lds
    s_add_u32 m0, s79, 105472
    s_add_u32 s78, s78, 9216
    buffer_load_dwordx4 v31, s[40:43], s78 offen nt lds
    s_add_u32 m0, s79, 106496
    s_add_u32 s78, s78, 9216
    buffer_load_dwordx4 v31, s[40:43], s78 offen nt lds
    s_waitcnt vmcnt(9)
    s_branch L_qnq
L_qnp:
    s_waitcnt vmcnt(0)
L_qnq:
    v_lshrrev_b32 v8, 4, v0
    v_lshlrev_b32 v9, 4, v8
    v_lshlrev_b32 v8, 3, v8
    v_bfe_u32 v10, v0, 2, 2
    v_add_u32 v8, v8, v10
    v_lshlrev_b32 v8, 7, v8
    v_and_b32 v10, 3, v0
    v_lshl_add_u32 v8, v10, 3, v8
    v_mul_u32_u24 v10, 1152, v10
    v_add_u32 v9, v9, v10
    s_lshl_b32 s78, s56, 5
    v_bfe_u32 v14, v0, 3, 2
    v_lshlrev_b32 v14, 5, v14
    v_and_b32 v14, 96, v14
    v_xor_b32 v14, s78, v14
    v_add_u32 v11, 12288, v8
    v_add_u32 v11, v11, v14
    v_add_u32 v12, 36864, v11
    v_lshlrev_b32 v13, 2, v0
    v_mov_b32 v16, 0
    v_mov_b32 v17, 0
    v_mov_b32 v18, 0
    v_mov_b32 v19, 0
    v_mov_b32 v29, 7936
    v_mov_b32 v30, 1
    s_mov_b32 s83, 1048576
    s_waitcnt vmcnt(9) lgkmcnt(0)
    s_add_u32 s94, s94, 1
    s_mov_b32 s38, 0xffff0000
    s_mov_b32 s39, 0xffff0000
    s_mov_b64 exec, 1
    ds_add_u32 v29, v30
    s_mov_b64 exec, -1
L_wxn:
    ds_read_b32 v30, v29
    s_sub_u32 s83, s83, 1
    s_cbranch_scc1 L_wxn_ok
    s_waitcnt lgkmcnt(0)
    v_cmp_gt_u32 vcc, 4, v30
    s_cbranch_vccnz L_wxn
L_wxn_ok:
    s_waitcnt lgkmcnt(0)
    ds_read_b128 v[32:35], v9 offset:0
    ds_read_b64_tr_b16 v[36:37], v11 offset:0
    ds_read_b64_tr_b16 v[38:39], v11 offset:512
    ds_read_b128 v[40:43], v9 offset:64
    ds_read_b64_tr_b16 v[44:45], v11 offset:4096
    ds_read_b64_tr_b16 v[46:47], v11 offset:4608
    ds_read_b128 v[48:51], v9 offset:128
    ds_read_b64_tr_b16 v[52:53], v11 offset:8192
    ds_read_b64_tr_b16 v[54:55], v11 offset:8704
    ds_read_b128 v[56:59], v9 offset:192
    ds_read_b64_tr_b16 v[60:61], v11 offset:12288
    ds_read_b64_tr_b16 v[62:63], v11 offset:12800
    s_waitcnt lgkmcnt(9)
    v_mfma_f32_16x16x32_bf16 v[16:19], v[32:35], v[36:39], v[16:19]
    ds_read_b128 v[64:67], v9 offset:256
    ds_read_b64_tr_b16 v[68:69], v11 offset:16384
    ds_read_b64_tr_b16 v[70:71], v11 offset:16896
    s_waitcnt lgkmcnt(9)
    v_mfma_f32_16x16x32_bf16 v[16:19], v[40:43], v[44:47], v[16:19]
    ds_read_b128 v[32:35], v9 offset:320
    ds_read_b64_tr_b16 v[36:37], v11 offset:20480
    ds_read_b64_tr_b16 v[38:39], v11 offset:20992
    s_waitcnt lgkmcnt(9)
    v_mfma_f32_16x16x32_bf16 v[16:19], v[48:51], v[52:55], v[16:19]
    ds_read_b128 v[40:43], v9 offset:384
    ds_read_b64_tr_b16 v[44:45], v11 offset:24576
    ds_read_b64_tr_b16 v[46:47], v11 offset:25088
    s_waitcnt lgkmcnt(9)
    v_mfma_f32_16x16x32_bf16 v[16:19], v[56:59], v[60:63], v[16:19]
    ds_read_b128 v[48:51], v9 offset:448
    ds_read_b64_tr_b16 v[52:53], v11 offset:28672
    ds_read_b64_tr_b16 v[54:55], v11 offset:29184
    s_waitcnt lgkmcnt(9)
    v_mfma_f32_16x16x32_bf16 v[16:19], v[64:67], v[68:71], v[16:19]
    ds_read_b128 v[56:59], v9 offset:512
    ds_read_b64_tr_b16 v[60:61], v11 offset:32768
    ds_read_b64_tr_b16 v[62:63], v11 offset:33280
    s_waitcnt lgkmcnt(9)
    v_mfma_f32_16x16x32_bf16 v[16:19], v[32:35], v[36:39], v[16:19]
    ds_read_b128 v[64:67], v9 offset:576
    ds_read_b64_tr_b16 v[68:69], v12 offset:0
    ds_read_b64_tr_b16 v[70:71], v12 offset:512
    s_waitcnt lgkmcnt(9)
    v_mfma_f32_16x16x32_bf16 v[16:19], v[40:43], v[44:47], v[16:19]
    ds_read_b128 v[32:35], v9 offset:640
    ds_read_b64_tr_b16 v[36:37], v12 offset:4096
    ds_read_b64_tr_b16 v[38:39], v12 offset:4608
    s_waitcnt lgkmcnt(9)
    v_mfma_f32_16x16x32_bf16 v[16:19], v[48:51], v[52:55], v[16:19]
    ds_read_b128 v[40:43], v9 offset:704
    ds_read_b64_tr_b16 v[44:45], v12 offset:8192
    ds_read_b64_tr_b16 v[46:47], v12 offset:8704
    s_waitcnt lgkmcnt(9)
    v_mfma_f32_16x16x32_bf16 v[16:19], v[56:59], v[60:63], v[16:19]
    ds_read_b128 v[48:51], v9 offset:768
    ds_read_b64_tr_b16 v[52:53], v12 offset:12288
    ds_read_b64_tr_b16 v[54:55], v12 offset:12800
    s_waitcnt lgkmcnt(9)
    v_mfma_f32_16x16x32_bf16 v[16:19], v[64:67], v[68:71], v[16:19]
    ds_read_b128 v[56:59], v9 offset:832
    ds_read_b64_tr_b16 v[60:61], v12 offset:16384
    ds_read_b64_tr_b16 v[62:63], v12 offset:16896
    s_waitcnt lgkmcnt(9)
    v_mfma_f32_16x16x32_bf16 v[16:19], v[32:35], v[36:39], v[16:19]
    ds_read_b128 v[64:67], v9 offset:896
    ds_read_b64_tr_b16 v[68:69], v12 offset:20480
    ds_read_b64_tr_b16 v[70:71], v12 offset:20992
    s_waitcnt lgkmcnt(9)
    v_mfma_f32_16x16x32_bf16 v[16:19], v[40:43], v[44:47], v[16:19]
    ds_read_b128 v[32:35], v9 offset:960
    ds_read_b64_tr_b16 v[36:37], v12 offset:24576
    ds_read_b64_tr_b16 v[38:39], v12 offset:25088
    s_waitcnt lgkmcnt(9)
    v_mfma_f32_16x16x32_bf16 v[16:19], v[48:51], v[52:55], v[16:19]
    ds_read_b128 v[40:43], v9 offset:1024
    ds_read_b64_tr_b16 v[44:45], v12 offset:28672
    ds_read_b64_tr_b16 v[46:47], v12 offset:29184
    s_waitcnt lgkmcnt(9)
    v_mfma_f32_16x16x32_bf16 v[16:19], v[56:59], v[60:63], v[16:19]
    ds_read_b128 v[48:51], v9 offset:1088
    ds_read_b64_tr_b16 v[52:53], v12 offset:32768
    ds_read_b64_tr_b16 v[54:55], v12 offset:33280
    s_waitcnt lgkmcnt(9)
    v_mfma_f32_16x16x32_bf16 v[16:19], v[64:67], v[68:71], v[16:19]
    s_waitcnt lgkmcnt(6)
    v_mfma_f32_16x16x32_bf16 v[16:19], v[32:35], v[36:39], v[16:19]
    s_waitcnt lgkmcnt(3)
    v_mfma_f32_16x16x32_bf16 v[16:19], v[40:43], v[44:47], v[16:19]
    s_waitcnt lgkmcnt(0)
    v_mfma_f32_16x16x32_bf16 v[16:19], v[48:51], v[52:55], v[16:19]
    v_add_u32 v21, s94, v0
    s_mov_b32 s78, 0x07060100
    s_nop 5
    v_cndmask_b32 v16, v16, v17, s[38:39]
    v_cndmask_b32 v18, v18, v19, s[38:39]
    v_cndmask_b32 v20, v16, v18, s[58:59]
    v_cvt_pk_bf16_f32 v20, v20, v20
    v_perm_b32 v20, v20, v21, s78
    buffer_store_dword v20, v13, s[44:47], s51 offen sc1
    s_cmp_lg_u32 s50, 8192
    s_cbranch_scc1 L_qnr
    s_lshl_b32 s81, s53, 7
    s_mov_b32 s40, s12
    s_mov_b32 s41, s13
    s_mov_b32 s42, 4718592
    s_mov_b32 s43, 0x20000
    s_mul_i32 s78, s52, 147456
    s_add_u32 s78, s78, s81
    s_mul_i32 s79, s56, 36864
    s_add_u32 s78, s78, s79
    s_lshl_b32 s79, s56, 12
    s_add_u32 m0, s79, 86016
    s_nop 0
    buffer_load_dwordx4 v31, s[40:43], s78 offen nt lds
    s_add_u32 m0, s79, 87040
    s_add_u32 s78, s78, 9216
    buffer_load_dwordx4 v31, s[40:43], s78 offen nt lds
    s_add_u32 m0, s79, 88064
    s_add_u32 s78, s78, 9216
    buffer_load_dwordx4 v31, s[40:43], s78 offen nt lds
    s_add_u32 m0, s79, 89088
    s_add_u32 s78, s78, 9216
    buffer_load_dwordx4 v31, s[40:43], s78 offen nt lds
    s_mov_b32 s40, s20
    s_mov_b32 s41, s21
    s_mov_b32 s42, 5308416
    s_mov_b32 s43, 0x20000
    s_mul_i32 s78, s52, 165888
    s_add_u32 s78, s78, s81
    s_mul_i32 s79, s57, 9216
    s_add_u32 s78, s78, s79
    s_lshl_b32 s79, s57, 10
    s_add_u32 m0, s79, 102400
    s_nop 0
    buffer_load_dwordx4 v31, s[40:43], s78 offen nt lds
    s_add_u32 m0, s79, 103424
    s_add_u32 s78, s78, 9216
    buffer_load_dwordx4 v31, s[40:43], s78 offen nt lds
    s_add_u32 m0, s79, 104448
    s_add_u32 s78, s78, 9216
    buffer_load_dwordx4 v31, s[40:43], s78 offen nt lds
    s_add_u32 m0, s79, 105472
    s_add_u32 s78, s78, 9216
    buffer_load_dwordx4 v31, s[40:43], s78 offen nt lds
    s_add_u32 m0, s79, 106496
    s_add_u32 s78, s78, 9216
    buffer_load_dwordx4 v31, s[40:43], s78 offen nt lds
L_qnr:
    s_cmp_lg_u32 s56, 3
    s_cbranch_scc1 L_ti0
    s_cmp_ge_u32 s2, 128
    s_cbranch_scc1 L_ti0
    v_mov_b32 v22, 0
    v_mov_b32 v23, s94
    v_lshlrev_b32 v24, 3, v0
    s_mov_b64 exec, 0xffff
    s_lshl_b32 s79, s2, 7
    s_add_u32 s79, s79, 1736704
    buffer_store_dwordx2 v[22:23], v24, s[44:47], s79 offen sc1
    s_mov_b64 exec, -1
L_ti0:
    v_lshrrev_b32 v14, 3, v0
    v_lshlrev_b32 v14, 8, v14
    v_and_b32 v15, 7, v0
    v_lshl_add_u32 v14, v15, 3, v14
    s_lshl_b32 s88, s56, 6
    s_lshl_b32 s89, s49, 11
    s_add_u32 s88, s88, s89
    s_add_u32 s88, s88, 1048576
    s_lshl_b32 s89, s56, 8
    v_lshl_add_u32 v3, v0, 2, s89
    s_lshl_b32 s89, s56, 2
    v_mov_b32 v2, s89
    s_lshl_b32 s89, s56, 4
    s_add_u32 s89, s89, s94
    v_lshl_add_u32 v18, v15, 1, s89
    v_add_u32 v19, 1, v18
    s_mov_b32 s83, 1048576
L_q_again0:
    buffer_load_dwordx2 v[16:17], v14, s[44:47], s88 offen sc1
    s_sub_u32 s83, s83, 1
    s_cbranch_scc1 L_q_got0
    s_waitcnt vmcnt(0)
    v_xor_b32 v15, v18, v16
    v_bitop3_b32 v15, v15, v17, v19 bitop3:0xf6
    v_and_b32 v15, 0xffff, v15
    v_cmp_ne_u32 vcc, 0, v15
    s_cbranch_vccnz L_q_again0
L_q_got0:
    s_mov_b32 s89, 0x07060302
    v_perm_b32 v16, v17, v16, s89
    v_mov_b32 v15, 1
    ds_write_b32 v3, v16 offset:8192
    ds_write_b32 v2, v15 offset:7952
    s_setprio 1
    s_branch L_tick
L_notask:
    s_lshl_b32 s81, s53, 7
    s_mov_b32 s40, s12
    s_mov_b32 s41, s13
    s_mov_b32 s42, 4718592
    s_mov_b32 s43, 0x20000
    s_mul_i32 s78, s52, 147456
    s_add_u32 s78, s78, s81
    s_mul_i32 s79, s56, 36864
    s_add_u32 s78, s78, s79
    s_lshl_b32 s79, s56, 12
    s_add_u32 m0, s79, 86016
    s_nop 0
    buffer_load_dwordx4 v31, s[40:43], s78 offen nt lds
    s_add_u32 m0, s79, 87040
    s_add_u32 s78, s78, 9216
    buffer_load_dwordx4 v31, s[40:43], s78 offen nt lds
    s_add_u32 m0, s79, 88064
    s_add_u32 s78, s78, 9216
    buffer_load_dwordx4 v31, s[40:43], s78 offen nt lds
    s_add_u32 m0, s79, 89088
    s_add_u32 s78, s78, 9216
    buffer_load_dwordx4 v31, s[40:43], s78 offen nt lds
    s_mov_b32 s40, s20
    s_mov_b32 s41, s21
    s_mov_b32 s42, 5308416
    s_mov_b32 s43, 0x20000
    s_mul_i32 s78, s52, 165888
    s_add_u32 s78, s78, s81
    s_mul_i32 s79, s57, 9216
    s_add_u32 s78, s78, s79
    s_lshl_b32 s79, s57, 10
    s_add_u32 m0, s79, 102400
    s_nop 0
    buffer_load_dwordx4 v31, s[40:43], s78 offen nt lds
    s_add_u32 m0, s79, 103424
    s_add_u32 s78, s78, 9216
    buffer_load_dwordx4 v31, s[40:43], s78 offen nt lds
    s_add_u32 m0, s79, 104448
    s_add_u32 s78, s78, 9216
    buffer_load_dwordx4 v31, s[40:43], s78 offen nt lds
    s_add_u32 m0, s79, 105472
    s_add_u32 s78, s78, 9216
    buffer_load_dwordx4 v31, s[40:43], s78 offen nt lds
    s_add_u32 m0, s79, 106496
    s_add_u32 s78, s78, 9216
    buffer_load_dwordx4 v31, s[40:43], s78 offen nt lds
    s_cmp_eq_u32 s98, 0
    s_cbranch_scc1 L_pj0
    s_mov_b32 s80, 8
    s_lshl_b32 s81, s80, 7
    s_mov_b32 s40, s12
    s_mov_b32 s41, s13
    s_mov_b32 s42, 4718592
    s_mov_b32 s43, 0x20000
    s_mul_i32 s78, s52, 147456
    s_add_u32 s78, s78, s81
    s_mul_i32 s79, s56, 36864
    s_add_u32 s78, s78, s79
    s_lshl_b32 s79, s56, 12
    s_add_u32 m0, s79, 12288
    s_nop 0
    buffer_load_dwordx4 v31, s[40:43], s78 offen nt lds
    s_add_u32 m0, s79, 13312
    s_add_u32 s78, s78, 9216
    buffer_load_dwordx4 v31, s[40:43], s78 offen nt lds
    s_add_u32 m0, s79, 14336
    s_add_u32 s78, s78, 9216
    buffer_load_dwordx4 v31, s[40:43], s78 offen nt lds
    s_add_u32 m0, s79, 15360
    s_add_u32 s78, s78, 9216
    buffer_load_dwordx4 v31, s[40:43], s78 offen nt lds
    s_mov_b32 s40, s20
    s_mov_b32 s41, s21
    s_mov_b32 s42, 5308416
    s_mov_b32 s43, 0x20000
    s_mul_i32 s78, s52, 165888
    s_add_u32 s78, s78, s81
    s_mul_i32 s79, s57, 9216
    s_add_u32 s78, s78, s79
    s_lshl_b32 s79, s57, 10
    s_add_u32 m0, s79, 28672
    s_nop 0
    buffer_load_dwordx4 v31, s[40:43], s78 offen nt lds
    s_add_u32 m0, s79, 29696
    s_add_u32 s78, s78, 9216
    buffer_load_dwordx4 v31, s[40:43], s78 offen nt lds
    s_add_u32 m0, s79, 30720
    s_add_u32 s78, s78, 9216
    buffer_load_dwordx4 v31, s[40:43], s78 offen nt lds
    s_add_u32 m0, s79, 31744
    s_add_u32 s78, s78, 9216
    buffer_load_dwordx4 v31, s[40:43], s78 offen nt lds
    s_add_u32 m0, s79, 32768
    s_add_u32 s78, s78, 9216
    buffer_load_dwordx4 v31, s[40:43], s78 offen nt lds
L_pj0:
    s_barrier
    s_waitcnt lgkmcnt(0)
    s_add_u32 s94, s94, 1
    s_mov_b32 s38, 0xffff0000
    s_mov_b32 s39, 0xffff0000
    s_cmp_lg_u32 s56, 3
    s_cbranch_scc1 L_ti1
    s_cmp_ge_u32 s2, 128
    s_cbranch_scc1 L_ti1
    v_mov_b32 v22, 0
    v_mov_b32 v23, s94
    v_lshlrev_b32 v24, 3, v0
    s_mov_b64 exec, 0xffff
    s_lshl_b32 s79, s2, 7
    s_add_u32 s79, s79, 1736704
    buffer_store_dwordx2 v[22:23], v24, s[44:47], s79 offen sc1
    s_mov_b64 exec, -1
L_ti1:
    v_lshrrev_b32 v14, 3, v0
    v_lshlrev_b32 v14, 8, v14
    v_and_b32 v15, 7, v0
    v_lshl_add_u32 v14, v15, 3, v14
    s_lshl_b32 s88, s56, 6
    s_lshl_b32 s89, s49, 11
    s_add_u32 s88, s88, s89
    s_add_u32 s88, s88, 1048576
    s_lshl_b32 s89, s56, 8
    v_lshl_add_u32 v3, v0, 2, s89
    s_lshl_b32 s89, s56, 2
    v_mov_b32 v2, s89
    s_lshl_b32 s89, s56, 4
    s_add_u32 s89, s89, s94
    v_lshl_add_u32 v18, v15, 1, s89
    v_add_u32 v19, 1, v18
    s_mov_b32 s83, 1048576
L_q_again1:
    buffer_load_dwordx2 v[16:17], v14, s[44:47], s88 offen sc1
    s_sub_u32 s83, s83, 1
    s_cbranch_scc1 L_q_got1
    s_waitcnt vmcnt(0)
    v_xor_b32 v15, v18, v16
    v_bitop3_b32 v15, v15, v17, v19 bitop3:0xf6
    v_and_b32 v15, 0xffff, v15
    v_cmp_ne_u32 vcc, 0, v15
    s_cbranch_vccnz L_q_again1
L_q_got1:
    s_mov_b32 s89, 0x07060302
    v_perm_b32 v16, v17, v16, s89
    v_mov_b32 v15, 1
    ds_write_b32 v3, v16 offset:8192
    ds_write_b32 v2, v15 offset:7952
    s_setprio 1
L_tick:
L_gu:
    v_min_u32 v8, 35, v0
    v_lshrrev_b32 v9, 2, v8
    v_lshlrev_b32 v9, 8, v9
    v_and_b32 v24, 3, v8
    s_lshl_b32 s78, s56, 4
    s_add_u32 s78, s78, s94
    v_lshl_add_u32 v44, v24, 2, s78
    v_add_u32 v45, 1, v44
    v_add_u32 v46, 2, v44
    v_add_u32 v47, 3, v44
    v_lshl_add_u32 v24, v24, 4, v9
    v_lshlrev_b32 v26, 3, v8
    s_mul_i32 s78, s56, 288
    v_add_u32 v26, s78, v26
    s_mul_i32 s78, s52, 2304
    s_lshl_b32 s79, s56, 6
    s_add_u32 s78, s78, s79
    s_add_u32 s78, s78, 1572864
    s_add_u32 s79, s78, 73728
    v_mov_b32 v29, 7936
    s_mov_b32 s83, 1048576
    s_setprio 0
L_late:
    ds_read_b32 v30, v29 offset:8
    s_sub_u32 s83, s83, 1
    s_cbranch_scc1 L_late_ok
    s_waitcnt lgkmcnt(0)
    v_cmp_eq_u32 vcc, 0, v30
    s_cbranch_vccnz L_late
L_late_ok:
    s_setprio 1
    s_waitcnt lgkmcnt(0)
    s_mov_b32 s83, 1048576
L_ph:
    buffer_load_dwordx4 v[32:35], v24, s[44:47], s78 offen sc1
    buffer_load_dwordx4 v[36:39], v24, s[44:47], s79 offen sc1
    s_sub_u32 s83, s83, 1
    s_cbranch_scc1 L_ph_done
    s_waitcnt vmcnt(0)
    v_xor_b32 v8, v44, v32
    v_bitop3_b32 v8, v8, v33, v45 bitop3:0xf6
    v_bitop3_b32 v8, v8, v34, v46 bitop3:0xf6
    v_bitop3_b32 v8, v8, v35, v47 bitop3:0xf6
    v_bitop3_b32 v8, v8, v36, v44 bitop3:0xf6
    v_bitop3_b32 v8, v8, v37, v45 bitop3:0xf6
    v_bitop3_b32 v8, v8, v38, v46 bitop3:0xf6
    v_bitop3_b32 v8, v8, v39, v47 bitop3:0xf6
    v_and_b32 v8, 0xffff, v8
    v_cmp_ne_u32 vcc, 0, v8
    s_cbranch_vccnz L_ph
L_ph_done:
    s_waitcnt vmcnt(0)
    v_and_b32 v32, 0xffff0000, v32
    v_and_b32 v33, 0xffff0000, v33
    v_and_b32 v34, 0xffff0000, v34
    v_and_b32 v35, 0xffff0000, v35
    v_and_b32 v36, 0xffff0000, v36
    v_and_b32 v37, 0xffff0000, v37
    v_and_b32 v38, 0xffff0000, v38
    v_and_b32 v39, 0xffff0000, v39
    s_mov_b32 s78, 0x3d372713
    s_mov_b32 s79, 0xc0135761
    v_mul_f32 v40, v32, v32
    v_mul_f32 v40, v40, v32
    v_fma_f32 v40, v40, s78, v32
    v_mul_f32 v40, s79, v40
    v_exp_f32 v40, v40
    s_nop 0
    v_add_f32 v40, 1.0, v40
    v_rcp_f32 v40, v40
    s_nop 0
    v_mul_f32 v40, v40, v32
    v_cvt_pk_bf16_f32 v40, v40, v40
    v_and_b32 v40, 0xffff0000, v40
    v_mul_f32 v40, v40, v36
    v_mul_f32 v41, v33, v33
    v_mul_f32 v41, v41, v33
    v_fma_f32 v41, v41, s78, v33
    v_mul_f32 v41, s79, v41
    v_exp_f32 v41, v41
    s_nop 0
    v_add_f32 v41, 1.0, v41
    v_rcp_f32 v41, v41
    s_nop 0
    v_mul_f32 v41, v41, v33
    v_cvt_pk_bf16_f32 v41, v41, v41
    v_and_b32 v41, 0xffff0000, v41
    v_mul_f32 v41, v41, v37
    v_mul_f32 v42, v34, v34
    v_mul_f32 v42, v42, v34
    v_fma_f32 v42, v42, s78, v34
    v_mul_f32 v42, s79, v42
    v_exp_f32 v42, v42
    s_nop 0
    v_add_f32 v42, 1.0, v42
    v_rcp_f32 v42, v42
    s_nop 0
    v_mul_f32 v42, v42, v34
    v_cvt_pk_bf16_f32 v42, v42, v42
    v_and_b32 v42, 0xffff0000, v42
    v_mul_f32 v42, v42, v38
    v_mul_f32 v43, v35, v35
    v_mul_f32 v43, v43, v35
    v_fma_f32 v43, v43, s78, v35
    v_mul_f32 v43, s79, v43
    v_exp_f32 v43, v43
    s_nop 0
    v_add_f32 v43, 1.0, v43
    v_rcp_f32 v43, v43
    s_nop 0
    v_mul_f32 v43, v43, v35
    v_cvt_pk_bf16_f32 v43, v43, v43
    v_and_b32 v43, 0xffff0000, v43
    v_mul_f32 v43, v43, v39
    v_cvt_pk_bf16_f32 v16, v40, v41
    v_cvt_pk_bf16_f32 v17, v42, v43
    ds_write_b64 v26, v[16:17] offset:5632
    v_lshrrev_b32 v8, 4, v0
    v_bfe_u32 v10, v0, 2, 2
    v_lshl_add_u32 v11, v8, 2, v10
    v_lshl_add_u32 v10, v8, 3, v10
    v_lshlrev_b32 v10, 7, v10
    v_lshlrev_b32 v11, 7, v11
    v_and_b32 v12, 3, v0
    v_lshlrev_b32 v13, 3, v12
    s_lshl_b32 s78, s56, 5
    v_add3_u32 v10, v10, v13, s78
    v_add3_u32 v11, v11, v13, s78
    v_add_u32 v4, 102400, v10
    v_add_u32 v5, 118784, v11
    v_add_u32 v6, 86016, v10
    v_add_u32 v100, 28672, v10
    v_add_u32 v101, 45056, v11
    v_add_u32 v102, 12288, v10
    v_mul_u32_u24 v13, 288, v12
    v_lshl_add_u32 v7, v8, 3, v13
    v_lshl_add_u32 v3, v8, 4, v13
    v_lshlrev_b32 v12, 8, v12
    v_lshl_add_u32 v30, v8, 4, v12
    s_lshl_b32 s79, s56, 9
    v_lshl_add_u32 v112, v0, 3, s79
    v_and_b32 v113, 7, v0
    v_lshlrev_b32 v113, 9, v113
    s_lshl_b32 s79, s56, 7
    v_add_u32 v113, s79, v113
    s_lshl_b32 s88, s52, 14
    s_add_u32 s88, s88, 131072
    s_add_u32 s89, s88, 4096
    s_add_u32 s90, s88, 8192
    s_add_u32 s91, s88, 12288
    s_lshl_b32 s92, s52, 12
    s_add_u32 s92, s92, 1179648
    v_and_b32 v29, 15, v0
    v_lshlrev_b32 v29, 4, v29
    v_lshl_add_u32 v29, v8, 2, v29
    s_lshl_b32 s79, s56, 8
    v_add_u32 v29, s79, v29
    v_lshlrev_b32 v114, 2, v0
    s_lshl_b32 s93, s52, 10
    s_add_u32 s93, s93, s79
    s_add_u32 s93, s93, 720896
    s_add_u32 s87, s93, 262144
    s_lshl_b32 s79, s53, 15
    s_add_u32 s93, s93, s79
    s_movk_i32 s82, 0xff
    v_add_u32 v103, s94, v0
    v_add_u32 v104, 64, v103
    s_lshl_b32 s79, s56, 6
    v_add_u32 v115, s79, v103
    v_mov_b32 v24, 0
    v_mov_b32 v25, 0
    v_mov_b32 v26, 0
    v_mov_b32 v27, 0
    v_mov_b32 v116, 0
    v_mov_b32 v117, 0
    v_mov_b32 v118, 0
    v_mov_b32 v119, 0
    s_waitcnt vmcnt(0) lgkmcnt(0)
    s_mov_b32 s83, 1048576
    s_barrier
    buffer_load_dwordx4 v[124:127], v113, s[44:47], s92 offen sc1
    buffer_load_dwordx2 v[10:11], v112, s[44:47], s88 offen offset:0 sc1
    buffer_load_dwordx2 v[12:13], v112, s[44:47], s88 offen offset:2048 sc1
    buffer_load_dwordx2 v[14:15], v112, s[44:47], s89 offen offset:0 sc1
    buffer_load_dwordx2 v[16:17], v112, s[44:47], s89 offen offset:2048 sc1
    buffer_load_dwordx2 v[18:19], v112, s[44:47], s90 offen offset:0 sc1
    buffer_load_dwordx2 v[20:21], v112, s[44:47], s90 offen offset:2048 sc1
    buffer_load_dwordx2 v[22:23], v112, s[44:47], s91 offen offset:0 sc1
    buffer_load_dwordx2 v[120:121], v112, s[44:47], s91 offen offset:2048 sc1
    ds_read_b128 v[48:51], v3 offset:5632
    ds_read_b128 v[52:55], v3 offset:5696
    ds_read_b128 v[56:59], v3 offset:5760
    ds_read_b128 v[60:63], v3 offset:5824
    ds_read_b64 v[66:67], v7 offset:5888
    ds_read_b64_tr_b16 v[32:33], v4 offset:0
    ds_read_b64_tr_b16 v[34:35], v4 offset:512
    ds_read_b64_tr_b16 v[36:37], v4 offset:4096
    ds_read_b64_tr_b16 v[38:39], v4 offset:4608
    ds_read_b64_tr_b16 v[40:41], v4 offset:8192
    ds_read_b64_tr_b16 v[42:43], v4 offset:8704
    ds_read_b64_tr_b16 v[44:45], v4 offset:12288
    ds_read_b64_tr_b16 v[46:47], v4 offset:12800
    ds_read_b64_tr_b16 v[64:65], v5
    s_waitcnt lgkmcnt(0)
    v_mfma_f32_16x16x32_bf16 v[24:27], v[48:51], v[32:35], v[24:27]
    v_mfma_f32_16x16x32_bf16 v[24:27], v[52:55], v[36:39], v[24:27]
    v_mfma_f32_16x16x32_bf16 v[24:27], v[56:59], v[40:43], v[24:27]
    v_mfma_f32_16x16x32_bf16 v[24:27], v[60:63], v[44:47], v[24:27]
    s_nop 5
    v_mfma_f32_16x16x16_bf16 v[24:27], v[66:67], v[64:65], v[24:27]
    ds_read_b64_tr_b16 v[68:69], v6 offset:0
    ds_read_b64_tr_b16 v[70:71], v6 offset:512
    ds_read_b64_tr_b16 v[72:73], v6 offset:4096
    ds_read_b64_tr_b16 v[74:75], v6 offset:4608
    ds_read_b64_tr_b16 v[76:77], v6 offset:8192
    ds_read_b64_tr_b16 v[78:79], v6 offset:8704
    ds_read_b64_tr_b16 v[80:81], v6 offset:12288
    ds_read_b64_tr_b16 v[82:83], v6 offset:12800
    s_cmp_eq_u32 s98, 0
    s_cbranch_scc1 L_dn0
    s_waitcnt lgkmcnt(0)
    ds_read_b64_tr_b16 v[32:33], v100 offset:0
    ds_read_b64_tr_b16 v[34:35], v100 offset:512
    ds_read_b64_tr_b16 v[36:37], v100 offset:4096
    ds_read_b64_tr_b16 v[38:39], v100 offset:4608
    ds_read_b64_tr_b16 v[40:41], v100 offset:8192
    ds_read_b64_tr_b16 v[42:43], v100 offset:8704
    ds_read_b64_tr_b16 v[44:45], v100 offset:12288
    ds_read_b64_tr_b16 v[46:47], v100 offset:12800
    ds_read_b64_tr_b16 v[64:65], v101
    s_waitcnt lgkmcnt(0)
    v_mfma_f32_16x16x32_bf16 v[116:119], v[48:51], v[32:35], v[116:119]
    v_mfma_f32_16x16x32_bf16 v[116:119], v[52:55], v[36:39], v[116:119]
    v_mfma_f32_16x16x32_bf16 v[116:119], v[56:59], v[40:43], v[116:119]
    v_mfma_f32_16x16x32_bf16 v[116:119], v[60:63], v[44:47], v[116:119]
    s_nop 5
    v_mfma_f32_16x16x16_bf16 v[116:119], v[66:67], v[64:65], v[116:119]
    ds_read_b64_tr_b16 v[84:85], v102 offset:0
    ds_read_b64_tr_b16 v[86:87], v102 offset:512
    ds_read_b64_tr_b16 v[88:89], v102 offset:4096
    ds_read_b64_tr_b16 v[90:91], v102 offset:4608
    ds_read_b64_tr_b16 v[92:93], v102 offset:8192
    ds_read_b64_tr_b16 v[94:95], v102 offset:8704
    ds_read_b64_tr_b16 v[96:97], v102 offset:12288
    ds_read_b64_tr_b16 v[98:99], v102 offset:12800
L_dn0:
    s_branch L_h1
L_h1_again:
    s_mov_b32 s86, 0
    v_xor_b32 v122, v103, v10
    v_bitop3_b32 v122, v122, v11, v104 bitop3:0xf6
    v_and_b32 v122, 0xff, v122
    v_cmp_ne_u32 vcc, 0, v122
    s_cmp_eq_u64 vcc, 0
    s_cselect_b32 s84, 1, 0
    s_or_b32 s86, s86, s84
    v_xor_b32 v122, v103, v12
    v_bitop3_b32 v122, v122, v13, v104 bitop3:0xf6
    v_and_b32 v122, 0xff, v122
    v_cmp_ne_u32 vcc, 0, v122
    s_cmp_eq_u64 vcc, 0
    s_cselect_b32 s84, 2, 0
    s_or_b32 s86, s86, s84
    v_xor_b32 v122, v103, v14
    v_bitop3_b32 v122, v122, v15, v104 bitop3:0xf6
    v_and_b32 v122, 0xff, v122
    v_cmp_ne_u32 vcc, 0, v122
    s_cmp_eq_u64 vcc, 0
    s_cselect_b32 s84, 4, 0
    s_or_b32 s86, s86, s84
    v_xor_b32 v122, v103, v16
    v_bitop3_b32 v122, v122, v17, v104 bitop3:0xf6
    v_and_b32 v122, 0xff, v122
    v_cmp_ne_u32 vcc, 0, v122
    s_cmp_eq_u64 vcc, 0
    s_cselect_b32 s84, 8, 0
    s_or_b32 s86, s86, s84
    v_xor_b32 v122, v103, v18
    v_bitop3_b32 v122, v122, v19, v104 bitop3:0xf6
    v_and_b32 v122, 0xff, v122
    v_cmp_ne_u32 vcc, 0, v122
    s_cmp_eq_u64 vcc, 0
    s_cselect_b32 s84, 16, 0
    s_or_b32 s86, s86, s84
    v_xor_b32 v122, v103, v20
    v_bitop3_b32 v122, v122, v21, v104 bitop3:0xf6
    v_and_b32 v122, 0xff, v122
    v_cmp_ne_u32 vcc, 0, v122
    s_cmp_eq_u64 vcc, 0
    s_cselect_b32 s84, 32, 0
    s_or_b32 s86, s86, s84
    v_xor_b32 v122, v103, v22
    v_bitop3_b32 v122, v122, v23, v104 bitop3:0xf6
    v_and_b32 v122, 0xff, v122
    v_cmp_ne_u32 vcc, 0, v122
    s_cmp_eq_u64 vcc, 0
    s_cselect_b32 s84, 64, 0
    s_or_b32 s86, s86, s84
    v_xor_b32 v122, v103, v120
    v_bitop3_b32 v122, v122, v121, v104 bitop3:0xf6
    v_and_b32 v122, 0xff, v122
    v_cmp_ne_u32 vcc, 0, v122
    s_cmp_eq_u64 vcc, 0
    s_cselect_b32 s84, 128, 0
    s_or_b32 s86, s86, s84
    buffer_load_dwordx4 v[124:127], v113, s[44:47], s92 offen sc1
    s_bitcmp1_b32 s86, 0
    s_cbranch_scc1 L_g0
    buffer_load_dwordx2 v[10:11], v112, s[44:47], s88 offen offset:0 sc1
L_g0:
    s_bitcmp1_b32 s86, 1
    s_cbranch_scc1 L_g1
    buffer_load_dwordx2 v[12:13], v112, s[44:47], s88 offen offset:2048 sc1
L_g1:
    s_bitcmp1_b32 s86, 2
    s_cbranch_scc1 L_g2
    buffer_load_dwordx2 v[14:15], v112, s[44:47], s89 offen offset:0 sc1
L_g2:
    s_bitcmp1_b32 s86, 3
    s_cbranch_scc1 L_g3
    buffer_load_dwordx2 v[16:17], v112, s[44:47], s89 offen offset:2048 sc1
L_g3:
    s_bitcmp1_b32 s86, 4
    s_cbranch_scc1 L_g4
    buffer_load_dwordx2 v[18:19], v112, s[44:47], s90 offen offset:0 sc1
L_g4:
    s_bitcmp1_b32 s86, 5
    s_cbranch_scc1 L_g5
    buffer_load_dwordx2 v[20:21], v112, s[44:47], s90 offen offset:2048 sc1
L_g5:
    s_bitcmp1_b32 s86, 6
    s_cbranch_scc1 L_g6
    buffer_load_dwordx2 v[22:23], v112, s[44:47], s91 offen offset:0 sc1
L_g6:
    s_bitcmp1_b32 s86, 7
    s_cbranch_scc1 L_g7
    buffer_load_dwordx2 v[120:121], v112, s[44:47], s91 offen offset:2048 sc1
L_g7:
L_h1:
    s_sub_u32 s83, s83, 1
    s_cbranch_scc1 L_h1_done
    s_waitcnt vmcnt(0)
    v_xor_b32 v122, v103, v10
    v_xor_b32 v123, v104, v11
    v_bitop3_b32 v122, v122, v12, v103 bitop3:0xf6
    v_bitop3_b32 v123, v123, v13, v104 bitop3:0xf6
    v_bitop3_b32 v122, v122, v14, v103 bitop3:0xf6
    v_bitop3_b32 v123, v123, v15, v104 bitop3:0xf6
    v_bitop3_b32 v122, v122, v16, v103 bitop3:0xf6
    v_bitop3_b32 v123, v123, v17, v104 bitop3:0xf6
    v_bitop3_b32 v122, v122, v18, v103 bitop3:0xf6
    v_bitop3_b32 v123, v123, v19, v104 bitop3:0xf6
    v_bitop3_b32 v122, v122, v20, v103 bitop3:0xf6
    v_bitop3_b32 v123, v123, v21, v104 bitop3:0xf6
    v_bitop3_b32 v122, v122, v22, v103 bitop3:0xf6
    v_bitop3_b32 v123, v123, v23, v104 bitop3:0xf6
    v_bitop3_b32 v122, v122, v120, v103 bitop3:0xf6
    v_bitop3_b32 v123, v123, v121, v104 bitop3:0xf6
    v_or_b32 v122, v122, v123
    v_and_b32 v122, 0xff, v122
    v_bitop3_b32 v122, v122, v126, s94 bitop3:0xf6
    v_bitop3_b32 v122, v122, v127, s94 bitop3:0xf6
    v_mov_b32 v8, v124
    v_mov_b32 v9, v125
    v_cmp_ne_u32 vcc, 0, v122
    s_cbranch_vccnz L_h1_again
L_h1_done:
    s_movk_i32 s84, 0xff00
    v_max_f32_dpp v122, v8, v8 quad_perm:[1,0,3,2] row_mask:0xf bank_mask:0xf
    v_and_b32 v10, s84, v10
    v_and_b32 v11, s84, v11
    v_and_b32 v12, s84, v12
    v_max_f32_dpp v122, v122, v122 quad_perm:[2,3,0,1] row_mask:0xf bank_mask:0xf
    v_and_b32 v13, s84, v13
    v_and_b32 v14, s84, v14
    v_and_b32 v15, s84, v15
    v_max_f32_dpp v122, v122, v122 row_half_mirror row_mask:0xf bank_mask:0xf
    v_sub_f32 v8, v8, v122
    v_mul_f32 v8, s85, v8
    v_exp_f32 v8, v8
    v_and_b32 v16, s84, v16
    v_and_b32 v17, s84, v17
    v_and_b32 v18, s84, v18
    v_and_b32 v19, s84, v19
    v_and_b32 v20, s84, v20
    v_mul_f32 v9, v9, v8
    v_and_b32 v21, s84, v21
    v_and_b32 v22, s84, v22
    v_and_b32 v23, s84, v23
    v_and_b32 v120, s84, v120
    v_and_b32 v121, s84, v121
    v_mul_f32_dpp v122, v8, v10 row_newbcast:0 row_mask:0xf bank_mask:0xf
    v_add_f32_dpp v9, v9, v9 quad_perm:[1,0,3,2] row_mask:0xf bank_mask:0xf
    v_mul_f32_dpp v123, v8, v11 row_newbcast:0 row_mask:0xf bank_mask:0xf
    v_fmac_f32_dpp v122, v8, v12 row_newbcast:1 row_mask:0xf bank_mask:0xf
    v_add_f32_dpp v9, v9, v9 quad_perm:[2,3,0,1] row_mask:0xf bank_mask:0xf
    v_fmac_f32_dpp v123, v8, v13 row_newbcast:1 row_mask:0xf bank_mask:0xf
    v_fmac_f32_dpp v122, v8, v14 row_newbcast:2 row_mask:0xf bank_mask:0xf
    v_add_f32_dpp v9, v9, v9 row_half_mirror row_mask:0xf bank_mask:0xf
    v_fmac_f32_dpp v123, v8, v15 row_newbcast:2 row_mask:0xf bank_mask:0xf
    v_rcp_f32 v9, v9
    v_fmac_f32_dpp v122, v8, v16 row_newbcast:3 row_mask:0xf bank_mask:0xf
    v_fmac_f32_dpp v123, v8, v17 row_newbcast:3 row_mask:0xf bank_mask:0xf
    v_fmac_f32_dpp v122, v8, v18 row_newbcast:4 row_mask:0xf bank_mask:0xf
    v_fmac_f32_dpp v123, v8, v19 row_newbcast:4 row_mask:0xf bank_mask:0xf
    v_fmac_f32_dpp v122, v8, v20 row_newbcast:5 row_mask:0xf bank_mask:0xf
    v_fmac_f32_dpp v123, v8, v21 row_newbcast:5 row_mask:0xf bank_mask:0xf
    v_fmac_f32_dpp v122, v8, v22 row_newbcast:6 row_mask:0xf bank_mask:0xf
    v_fmac_f32_dpp v123, v8, v23 row_newbcast:6 row_mask:0xf bank_mask:0xf
    v_fmac_f32_dpp v122, v8, v120 row_newbcast:7 row_mask:0xf bank_mask:0xf
    v_fmac_f32_dpp v123, v8, v121 row_newbcast:7 row_mask:0xf bank_mask:0xf
    v_mul_f32 v122, v122, v9
    v_mul_f32 v123, v123, v9
    v_cvt_pk_bf16_f32 v122, v122, v123
    ds_write_b32 v29, v122 offset:6912
    s_waitcnt lgkmcnt(0)
    s_barrier
    ds_read_b128 v[48:51], v30 offset:6912
    ds_read_b128 v[52:55], v30 offset:6976
    ds_read_b128 v[56:59], v30 offset:7040
    ds_read_b128 v[60:63], v30 offset:7104
    s_waitcnt lgkmcnt(3)
    v_mfma_f32_16x16x32_bf16 v[24:27], v[48:51], v[68:71], v[24:27]
    s_waitcnt lgkmcnt(2)
    v_mfma_f32_16x16x32_bf16 v[24:27], v[52:55], v[72:75], v[24:27]
    s_waitcnt lgkmcnt(1)
    v_mfma_f32_16x16x32_bf16 v[24:27], v[56:59], v[76:79], v[24:27]
    s_waitcnt lgkmcnt(0)
    v_mfma_f32_16x16x32_bf16 v[24:27], v[60:63], v[80:83], v[24:27]
    s_cmp_eq_u32 s98, 0
    s_cbranch_scc1 L_y1
    v_mfma_f32_16x16x32_bf16 v[116:119], v[48:51], v[84:87], v[116:119]
    v_mfma_f32_16x16x32_bf16 v[116:119], v[52:55], v[88:91], v[116:119]
    v_mfma_f32_16x16x32_bf16 v[116:119], v[56:59], v[92:95], v[116:119]
    v_mfma_f32_16x16x32_bf16 v[116:119], v[60:63], v[96:99], v[116:119]
    s_nop 7
    v_cndmask_b32 v116, v116, v117, s[38:39]
    v_cndmask_b32 v118, v118, v119, s[38:39]
    v_cndmask_b32 v116, v116, v118, s[58:59]
    v_bfi_b32 v116, s82, v115, v116
    buffer_store_dword v116, v114, s[44:47], s87 offen sc1
L_y1:
    s_nop 7
    v_cndmask_b32 v24, v24, v25, s[38:39]
    v_cndmask_b32 v26, v26, v27, s[38:39]
    v_cndmask_b32 v24, v24, v26, s[58:59]
    v_bfi_b32 v24, s82, v115, v24
    buffer_store_dword v24, v114, s[44:47], s93 offen sc1
L_done:
    s_mov_b64 exec, -1
L_end:
    s_endpgm
L_stream:
    s_add_u32 s56, s3, s48
    s_and_b32 s56, s56, 3
    s_lshl_b32 s58, s56, 5
    s_add_u32 s58, s58, s49
    s_lshl_b32 s59, s58, 21
    s_add_u32 s28, s6, s59
    s_addc_u32 s29, s7, 0
    s_mov_b32 s30, 2097152
    s_mov_b32 s31, 0x20000
    s_add_u32 s32, s8, s59
    s_addc_u32 s33, s9, 0
    s_bfe_u32 s50, s48, 0x10001
    s_lshr_b32 s51, s48, 2
    s_lshl_b32 s51, s51, 1
    s_and_b32 s92, s48, 1
    s_add_u32 s51, s51, s92
    s_lshl_b32 s54, s50, 13
    s_lshl_b32 s34, s58, 14
    s_add_u32 s34, s34, 2097152
    s_lshl_b32 s58, s58, 7
    s_add_u32 s58, s58, 1736704
    s_add_u32 s36, s26, s58
    s_addc_u32 s37, s27, 0
    s_lshl_b32 s35, s3, 11
    s_add_u32 s35, s35, 120832
    v_bfe_u32 v3, v0, 4, 1
    v_lshlrev_b32 v3, 15, v3
    v_bfe_u32 v2, v0, 5, 1
    v_lshl_or_b32 v3, v2, 8, v3
    v_and_b32 v2, 15, v0
    v_lshl_or_b32 v2, v2, 4, v3
    s_barrier
    s_lshr_b32 s76, s51, 2
    s_lshl_b32 s76, s76, 16
    s_and_b32 s92, s51, 1
    s_lshl_b32 s92, s92, 12
    s_add_u32 s76, s76, s92
    s_and_b32 s92, s51, 2
    s_lshl_b32 s92, s92, 13
    s_add_u32 s76, s76, s92
    s_add_u32 s76, s76, s54
    s_add_u32 s51, s51, 4
    s_add_u32 s10, s35, 0
    buffer_load_dwordx4 v[32:35], v2, s[28:31], s76 offen offset:0 nt
    buffer_load_dwordx4 v[36:39], v2, s[28:31], s76 offen offset:512 nt
    buffer_load_dwordx4 v[40:43], v2, s[28:31], s76 offen offset:1024 nt
    buffer_load_dwordx4 v[44:47], v2, s[28:31], s76 offen offset:1536 nt
    buffer_load_dwordx4 v[48:51], v2, s[28:31], s76 offen offset:2048 nt
    buffer_load_dwordx4 v[52:55], v2, s[28:31], s76 offen offset:2560 nt
    buffer_load_dwordx4 v[56:59], v2, s[28:31], s76 offen offset:3072 nt
    buffer_load_dwordx4 v[60:63], v2, s[28:31], s76 offen offset:3584 nt
    s_lshr_b32 s76, s51, 2
    s_lshl_b32 s76, s76, 16
    s_and_b32 s92, s51, 1
    s_lshl_b32 s92, s92, 12
    s_add_u32 s76, s76, s92
    s_and_b32 s92, s51, 2
    s_lshl_b32 s92, s92, 13
    s_add_u32 s76, s76, s92
    s_add_u32 s76, s76, s54
    s_add_u32 s51, s51, 4
    s_add_u32 s11, s35, 64
    buffer_load_dwordx4 v[64:67], v2, s[28:31], s76 offen offset:0 nt
    buffer_load_dwordx4 v[68:71], v2, s[28:31], s76 offen offset:512 nt
    buffer_load_dwordx4 v[72:75], v2, s[28:31], s76 offen offset:1024 nt
    buffer_load_dwordx4 v[76:79], v2, s[28:31], s76 offen offset:1536 nt
    buffer_load_dwordx4 v[80:83], v2, s[28:31], s76 offen offset:2048 nt
    buffer_load_dwordx4 v[84:87], v2, s[28:31], s76 offen offset:2560 nt
    buffer_load_dwordx4 v[88:91], v2, s[28:31], s76 offen offset:3072 nt
    buffer_load_dwordx4 v[92:95], v2, s[28:31], s76 offen offset:3584 nt
    s_lshr_b32 s76, s51, 2
    s_lshl_b32 s76, s76, 16
    s_and_b32 s92, s51, 1
    s_lshl_b32 s92, s92, 12
    s_add_u32 s76, s76, s92
    s_and_b32 s92, s51, 2
    s_lshl_b32 s92, s92, 13
    s_add_u32 s76, s76, s92
    s_add_u32 s76, s76, s54
    s_add_u32 s51, s51, 4
    s_add_u32 s12, s35, 128
    buffer_load_dwordx4 v[96:99], v2, s[28:31], s76 offen offset:0 nt
    buffer_load_dwordx4 v[100:103], v2, s[28:31], s76 offen offset:512 nt
    buffer_load_dwordx4 v[104:107], v2, s[28:31], s76 offen offset:1024 nt
    buffer_load_dwordx4 v[108:111], v2, s[28:31], s76 offen offset:1536 nt
    buffer_load_dwordx4 v[112:115], v2, s[28:31], s76 offen offset:2048 nt
    buffer_load_dwordx4 v[116:119], v2, s[28:31], s76 offen offset:2560 nt
    buffer_load_dwordx4 v[120:123], v2, s[28:31], s76 offen offset:3072 nt
    buffer_load_dwordx4 v[124:127], v2, s[28:31], s76 offen offset:3584 nt
    s_lshr_b32 s76, s51, 2
    s_lshl_b32 s76, s76, 16
    s_and_b32 s92, s51, 1
    s_lshl_b32 s92, s92, 12
    s_add_u32 s76, s76, s92
    s_and_b32 s92, s51, 2
    s_lshl_b32 s92, s92, 13
    s_add_u32 s76, s76, s92
    s_add_u32 s76, s76, s54
    s_add_u32 s51, s51, 4
    s_add_u32 s13, s35, 192
    buffer_load_dwordx4 v[128:131], v2, s[28:31], s76 offen offset:0 nt
    buffer_load_dwordx4 v[132:135], v2, s[28:31], s76 offen offset:512 nt
    buffer_load_dwordx4 v[136:139], v2, s[28:31], s76 offen offset:1024 nt
    buffer_load_dwordx4 v[140:143], v2, s[28:31], s76 offen offset:1536 nt
    buffer_load_dwordx4 v[144:147], v2, s[28:31], s76 offen offset:2048 nt
    buffer_load_dwordx4 v[148:151], v2, s[28:31], s76 offen offset:2560 nt
    buffer_load_dwordx4 v[152:155], v2, s[28:31], s76 offen offset:3072 nt
    buffer_load_dwordx4 v[156:159], v2, s[28:31], s76 offen offset:3584 nt
    s_lshl_b32 s78, s56, 2
    v_mov_b32 v9, s78
    v_and_b32 v3, 15, v0
    v_lshlrev_b32 v3, 4, v3
    s_lshl_b32 s78, s56, 8
    v_add_u32 v3, s78, v3
    s_mov_b32 s83, 1048576
L_qw:
    ds_read_b32 v8, v9 offset:7952
    ds_read_b128 v[4:7], v3 offset:8192
    s_sub_u32 s83, s83, 1
    s_cbranch_scc1 L_q_ok
    s_waitcnt lgkmcnt(0)
    v_cmp_eq_u32 vcc, 0, v8
    s_cbranch_vccnz L_qw
L_q_ok:
    s_waitcnt lgkmcnt(0)
    s_add_u32 s94, s94, 1
    v_mov_b32 v8, 0
    v_mov_b32 v9, 0
    v_mov_b32 v10, 0
    v_mov_b32 v11, 0
    v_mov_b32 v12, 0
    v_mov_b32 v13, 0
    v_mov_b32 v14, 0
    v_mov_b32 v15, 0
    v_mov_b32 v16, 0xff7fffff
    v_mov_b32 v17, 0
    s_mov_b32 s84, 1035273459
    s_mov_b32 s86, 0xffff0000
    v_and_b32 v28, 0x3c, v0
    v_lshlrev_b32 v3, 1, v28
    v_lshrrev_b32 v30, 1, v0
    v_lshlrev_b32 v30, 2, v30
    v_and_b32 v31, 1, v0
    v_add_lshl_u32 v30, v30, v31, 2
    v_lshlrev_b32 v31, 2, v0
    s_mov_b32 s87, 4
    s_mov_b32 s88, 4
    s_mov_b32 s77, 0
    s_mov_b32 s55, 0
    s_mov_b32 s89, 0
    s_lshr_b32 s17, s48, 2
    s_add_u32 s17, s17, 96
    s_bitcmp0_b32 s48, 0
    s_cselect_b32 s14, 28, 24
    s_cmp_eq_u32 s50, 0
    s_cselect_b32 s15, 24, 24
    s_cselect_b32 s16, 24, 24
    s_mov_b32 s80, 0xaaaaaaaa
    s_mov_b32 s81, 0xaaaaaaaa
    s_mov_b32 s83, 1048576
L_A0:
    s_cmp_eq_u32 s77, 0
    s_cbranch_scc1 L_need0L_ha0
L_ha0:
    s_sub_u32 s77, s77, 1
    s_lshr_b32 s76, s57, 2
    s_lshl_b32 s76, s76, 16
    s_and_b32 s92, s57, 1
    s_lshl_b32 s92, s92, 12
    s_add_u32 s76, s76, s92
    s_and_b32 s92, s57, 2
    s_lshl_b32 s92, s92, 13
    s_add_u32 s76, s76, s92
    s_add_u32 s76, s76, s54
    s_lshr_b32 s42, s57, 1
    s_lshl_b32 s42, s42, 8
    s_lshr_b32 s92, s54, 6
    s_add_u32 s42, s42, s92
    s_and_b32 s92, s57, 1
    s_lshl_b32 s92, s92, 0
    s_and_b32 s92, s92, 4
    s_add_u32 s42, s42, s92
    s_add_u32 s42, s42, s34
    s_add_u32 s57, s57, 1
L_ha0_go:
    s_waitcnt vmcnt(24)
    v_dot2_f32_bf16 v18, v32, v4, 0
    v_dot2_f32_bf16 v19, v36, v4, 0
    v_dot2_f32_bf16 v20, v40, v4, 0
    v_dot2_f32_bf16 v21, v44, v4, 0
    v_dot2_f32_bf16 v22, v48, v4, 0
    v_dot2_f32_bf16 v23, v52, v4, 0
    v_dot2_f32_bf16 v24, v56, v4, 0
    v_dot2_f32_bf16 v25, v60, v4, 0
    v_dot2c_f32_bf16 v18, v33, v5
    v_dot2c_f32_bf16 v19, v37, v5
    v_dot2c_f32_bf16 v20, v41, v5
    v_dot2c_f32_bf16 v21, v45, v5
    v_dot2c_f32_bf16 v22, v49, v5
    v_dot2c_f32_bf16 v23, v53, v5
    v_dot2c_f32_bf16 v24, v57, v5
    v_dot2c_f32_bf16 v25, v61, v5
    v_dot2c_f32_bf16 v18, v34, v6
    v_dot2c_f32_bf16 v19, v38, v6
    v_dot2c_f32_bf16 v20, v42, v6
    v_dot2c_f32_bf16 v21, v46, v6
    v_dot2c_f32_bf16 v22, v50, v6
    v_dot2c_f32_bf16 v23, v54, v6
    v_dot2c_f32_bf16 v24, v58, v6
    v_dot2c_f32_bf16 v25, v62, v6
    v_dot2c_f32_bf16 v18, v35, v7
    v_dot2c_f32_bf16 v19, v39, v7
    v_dot2c_f32_bf16 v20, v43, v7
    v_dot2c_f32_bf16 v21, v47, v7
    v_dot2c_f32_bf16 v22, v51, v7
    v_dot2c_f32_bf16 v23, v55, v7
    v_dot2c_f32_bf16 v24, v59, v7
    v_dot2c_f32_bf16 v25, v63, v7
    s_mov_b32 s43, s10
    s_mov_b32 s10, s42
    buffer_load_dwordx4 v[32:35], v2, s[28:31], s76 offen offset:0 nt
    buffer_load_dwordx4 v[36:39], v2, s[28:31], s76 offen offset:512 nt
    buffer_load_dwordx4 v[40:43], v2, s[28:31], s76 offen offset:1024 nt
    buffer_load_dwordx4 v[44:47], v2, s[28:31], s76 offen offset:1536 nt
    buffer_load_dwordx4 v[48:51], v2, s[28:31], s76 offen offset:2048 nt
    buffer_load_dwordx4 v[52:55], v2, s[28:31], s76 offen offset:2560 nt
    buffer_load_dwordx4 v[56:59], v2, s[28:31], s76 offen offset:3072 nt
    buffer_load_dwordx4 v[60:63], v2, s[28:31], s76 offen offset:3584 nt
    v_add_f32_dpp v26, v18, v18 row_ror:8 row_mask:0xf bank_mask:0x3
    v_add_f32_dpp v27, v20, v20 row_ror:8 row_mask:0xf bank_mask:0x3
    v_add_f32_dpp v26, v19, v19 row_ror:8 row_mask:0xf bank_mask:0xc
    v_add_f32_dpp v27, v21, v21 row_ror:8 row_mask:0xf bank_mask:0xc
    v_add_f32_dpp v20, v22, v22 row_ror:8 row_mask:0xf bank_mask:0x3
    v_add_f32_dpp v21, v24, v24 row_ror:8 row_mask:0xf bank_mask:0x3
    v_add_f32_dpp v20, v23, v23 row_ror:8 row_mask:0xf bank_mask:0xc
    v_add_f32_dpp v21, v25, v25 row_ror:8 row_mask:0xf bank_mask:0xc
    v_add_f32_dpp v18, v26, v26 row_half_mirror row_mask:0xf bank_mask:0x5
    v_add_f32_dpp v18, v27, v27 row_half_mirror row_mask:0xf bank_mask:0xa
    v_add_f32_dpp v19, v20, v20 row_half_mirror row_mask:0xf bank_mask:0x5
    v_add_f32_dpp v19, v21, v21 row_half_mirror row_mask:0xf bank_mask:0xa
    s_nop 0
    v_add_f32_dpp v18, v18, v18 quad_perm:[1,0,3,2] row_mask:0xf bank_mask:0xf
    v_add_f32_dpp v19, v19, v19 quad_perm:[1,0,3,2] row_mask:0xf bank_mask:0xf
    s_nop 0
    v_add_f32_dpp v18, v18, v18 quad_perm:[2,3,0,1] row_mask:0xf bank_mask:0xf
    v_add_f32_dpp v19, v19, v19 quad_perm:[2,3,0,1] row_mask:0xf bank_mask:0xf
    v_cvt_pk_bf16_f32 v18, v18, v19
    v_lshlrev_b32 v20, 16, v18
    v_and_b32 v21, s86, v18
    v_mul_f32 v20, s84, v20
    v_mul_f32 v21, s84, v21
    v_cvt_pk_bf16_f32 v18, v20, v21
    s_cmp_ge_u32 s43, 2097152
    s_cbranch_scc1 L_pub0
    v_add_u32 v26, s43, v28
    ds_write_b32 v26, v18
    s_branch L_pe0
L_pub0:
    v_mov_b32 v29, v18
L_pe0:
L_A1:
    s_cmp_eq_u32 s77, 0
    s_cbranch_scc1 L_need0L_ha1
L_ha1:
    s_sub_u32 s77, s77, 1
    s_lshr_b32 s76, s57, 2
    s_lshl_b32 s76, s76, 16
    s_and_b32 s92, s57, 1
    s_lshl_b32 s92, s92, 12
    s_add_u32 s76, s76, s92
    s_and_b32 s92, s57, 2
    s_lshl_b32 s92, s92, 13
    s_add_u32 s76, s76, s92
    s_add_u32 s76, s76, s54
    s_lshr_b32 s42, s57, 1
    s_lshl_b32 s42, s42, 8
    s_lshr_b32 s92, s54, 6
    s_add_u32 s42, s42, s92
    s_and_b32 s92, s57, 1
    s_lshl_b32 s92, s92, 0
    s_and_b32 s92, s92, 4
    s_add_u32 s42, s42, s92
    s_add_u32 s42, s42, s34
    s_add_u32 s57, s57, 1
L_ha1_go:
    s_waitcnt vmcnt(24)
    v_dot2_f32_bf16 v18, v64, v4, 0
    v_dot2_f32_bf16 v19, v68, v4, 0
    v_dot2_f32_bf16 v20, v72, v4, 0
    v_dot2_f32_bf16 v21, v76, v4, 0
    v_dot2_f32_bf16 v22, v80, v4, 0
    v_dot2_f32_bf16 v23, v84, v4, 0
    v_dot2_f32_bf16 v24, v88, v4, 0
    v_dot2_f32_bf16 v25, v92, v4, 0
    v_dot2c_f32_bf16 v18, v65, v5
    v_dot2c_f32_bf16 v19, v69, v5
    v_dot2c_f32_bf16 v20, v73, v5
    v_dot2c_f32_bf16 v21, v77, v5
    v_dot2c_f32_bf16 v22, v81, v5
    v_dot2c_f32_bf16 v23, v85, v5
    v_dot2c_f32_bf16 v24, v89, v5
    v_dot2c_f32_bf16 v25, v93, v5
    v_dot2c_f32_bf16 v18, v66, v6
    v_dot2c_f32_bf16 v19, v70, v6
    v_dot2c_f32_bf16 v20, v74, v6
    v_dot2c_f32_bf16 v21, v78, v6
    v_dot2c_f32_bf16 v22, v82, v6
    v_dot2c_f32_bf16 v23, v86, v6
    v_dot2c_f32_bf16 v24, v90, v6
    v_dot2c_f32_bf16 v25, v94, v6
    v_dot2c_f32_bf16 v18, v67, v7
    v_dot2c_f32_bf16 v19, v71, v7
    v_dot2c_f32_bf16 v20, v75, v7
    v_dot2c_f32_bf16 v21, v79, v7
    v_dot2c_f32_bf16 v22, v83, v7
    v_dot2c_f32_bf16 v23, v87, v7
    v_dot2c_f32_bf16 v24, v91, v7
    v_dot2c_f32_bf16 v25, v95, v7
    s_mov_b32 s43, s11
    s_mov_b32 s11, s42
    buffer_load_dwordx4 v[64:67], v2, s[28:31], s76 offen offset:0 nt
    buffer_load_dwordx4 v[68:71], v2, s[28:31], s76 offen offset:512 nt
    buffer_load_dwordx4 v[72:75], v2, s[28:31], s76 offen offset:1024 nt
    buffer_load_dwordx4 v[76:79], v2, s[28:31], s76 offen offset:1536 nt
    buffer_load_dwordx4 v[80:83], v2, s[28:31], s76 offen offset:2048 nt
    buffer_load_dwordx4 v[84:87], v2, s[28:31], s76 offen offset:2560 nt
    buffer_load_dwordx4 v[88:91], v2, s[28:31], s76 offen offset:3072 nt
    buffer_load_dwordx4 v[92:95], v2, s[28:31], s76 offen offset:3584 nt
    v_add_f32_dpp v26, v18, v18 row_ror:8 row_mask:0xf bank_mask:0x3
    v_add_f32_dpp v27, v20, v20 row_ror:8 row_mask:0xf bank_mask:0x3
    v_add_f32_dpp v26, v19, v19 row_ror:8 row_mask:0xf bank_mask:0xc
    v_add_f32_dpp v27, v21, v21 row_ror:8 row_mask:0xf bank_mask:0xc
    v_add_f32_dpp v20, v22, v22 row_ror:8 row_mask:0xf bank_mask:0x3
    v_add_f32_dpp v21, v24, v24 row_ror:8 row_mask:0xf bank_mask:0x3
    v_add_f32_dpp v20, v23, v23 row_ror:8 row_mask:0xf bank_mask:0xc
    v_add_f32_dpp v21, v25, v25 row_ror:8 row_mask:0xf bank_mask:0xc
    v_add_f32_dpp v18, v26, v26 row_half_mirror row_mask:0xf bank_mask:0x5
    v_add_f32_dpp v18, v27, v27 row_half_mirror row_mask:0xf bank_mask:0xa
    v_add_f32_dpp v19, v20, v20 row_half_mirror row_mask:0xf bank_mask:0x5
    v_add_f32_dpp v19, v21, v21 row_half_mirror row_mask:0xf bank_mask:0xa
    s_nop 0
    v_add_f32_dpp v18, v18, v18 quad_perm:[1,0,3,2] row_mask:0xf bank_mask:0xf
    v_add_f32_dpp v19, v19, v19 quad_perm:[1,0,3,2] row_mask:0xf bank_mask:0xf
    s_nop 0
    v_add_f32_dpp v18, v18, v18 quad_perm:[2,3,0,1] row_mask:0xf bank_mask:0xf
    v_add_f32_dpp v19, v19, v19 quad_perm:[2,3,0,1] row_mask:0xf bank_mask:0xf
    v_cvt_pk_bf16_f32 v18, v18, v19
    v_lshlrev_b32 v20, 16, v18
    v_and_b32 v21, s86, v18
    v_mul_f32 v20, s84, v20
    v_mul_f32 v21, s84, v21
    v_cvt_pk_bf16_f32 v18, v20, v21
    s_cmp_ge_u32 s43, 2097152
    s_cbranch_scc1 L_pub1
    v_add_u32 v26, s43, v28
    ds_write_b32 v26, v18
    s_branch L_pe1
L_pub1:
    v_cndmask_b32 v18, v29, v18, s[80:81]
    ds_bpermute_b32 v19, v30, v18
    s_mov_b64 exec, 0xffffffff
    s_waitcnt lgkmcnt(0)
    buffer_store_dword v19, v31, s[44:47], s43 offen sc1
    s_mov_b64 exec, -1
L_pe1:
L_A2:
    s_cmp_eq_u32 s77, 0
    s_cbranch_scc1 L_need0L_ha2
L_ha2:
    s_sub_u32 s77, s77, 1
    s_lshr_b32 s76, s57, 2
    s_lshl_b32 s76, s76, 16
    s_and_b32 s92, s57, 1
    s_lshl_b32 s92, s92, 12
    s_add_u32 s76, s76, s92
    s_and_b32 s92, s57, 2
    s_lshl_b32 s92, s92, 13
    s_add_u32 s76, s76, s92
    s_add_u32 s76, s76, s54
    s_lshr_b32 s42, s57, 1
    s_lshl_b32 s42, s42, 8
    s_lshr_b32 s92, s54, 6
    s_add_u32 s42, s42, s92
    s_and_b32 s92, s57, 1
    s_lshl_b32 s92, s92, 0
    s_and_b32 s92, s92, 4
    s_add_u32 s42, s42, s92
    s_add_u32 s42, s42, s34
    s_add_u32 s57, s57, 1
L_ha2_go:
    s_waitcnt vmcnt(24)
    v_dot2_f32_bf16 v18, v96, v4, 0
    v_dot2_f32_bf16 v19, v100, v4, 0
    v_dot2_f32_bf16 v20, v104, v4, 0
    v_dot2_f32_bf16 v21, v108, v4, 0
    v_dot2_f32_bf16 v22, v112, v4, 0
    v_dot2_f32_bf16 v23, v116, v4, 0
    v_dot2_f32_bf16 v24, v120, v4, 0
    v_dot2_f32_bf16 v25, v124, v4, 0
    v_dot2c_f32_bf16 v18, v97, v5
    v_dot2c_f32_bf16 v19, v101, v5
    v_dot2c_f32_bf16 v20, v105, v5
    v_dot2c_f32_bf16 v21, v109, v5
    v_dot2c_f32_bf16 v22, v113, v5
    v_dot2c_f32_bf16 v23, v117, v5
    v_dot2c_f32_bf16 v24, v121, v5
    v_dot2c_f32_bf16 v25, v125, v5
    v_dot2c_f32_bf16 v18, v98, v6
    v_dot2c_f32_bf16 v19, v102, v6
    v_dot2c_f32_bf16 v20, v106, v6
    v_dot2c_f32_bf16 v21, v110, v6
    v_dot2c_f32_bf16 v22, v114, v6
    v_dot2c_f32_bf16 v23, v118, v6
    v_dot2c_f32_bf16 v24, v122, v6
    v_dot2c_f32_bf16 v25, v126, v6
    v_dot2c_f32_bf16 v18, v99, v7
    v_dot2c_f32_bf16 v19, v103, v7
    v_dot2c_f32_bf16 v20, v107, v7
    v_dot2c_f32_bf16 v21, v111, v7
    v_dot2c_f32_bf16 v22, v115, v7
    v_dot2c_f32_bf16 v23, v119, v7
    v_dot2c_f32_bf16 v24, v123, v7
    v_dot2c_f32_bf16 v25, v127, v7
    s_mov_b32 s43, s12
    s_mov_b32 s12, s42
    buffer_load_dwordx4 v[96:99], v2, s[28:31], s76 offen offset:0 nt
    buffer_load_dwordx4 v[100:103], v2, s[28:31], s76 offen offset:512 nt
    buffer_load_dwordx4 v[104:107], v2, s[28:31], s76 offen offset:1024 nt
    buffer_load_dwordx4 v[108:111], v2, s[28:31], s76 offen offset:1536 nt
    buffer_load_dwordx4 v[112:115], v2, s[28:31], s76 offen offset:2048 nt
    buffer_load_dwordx4 v[116:119], v2, s[28:31], s76 offen offset:2560 nt
    buffer_load_dwordx4 v[120:123], v2, s[28:31], s76 offen offset:3072 nt
    buffer_load_dwordx4 v[124:127], v2, s[28:31], s76 offen offset:3584 nt
    v_add_f32_dpp v26, v18, v18 row_ror:8 row_mask:0xf bank_mask:0x3
    v_add_f32_dpp v27, v20, v20 row_ror:8 row_mask:0xf bank_mask:0x3
    v_add_f32_dpp v26, v19, v19 row_ror:8 row_mask:0xf bank_mask:0xc
    v_add_f32_dpp v27, v21, v21 row_ror:8 row_mask:0xf bank_mask:0xc
    v_add_f32_dpp v20, v22, v22 row_ror:8 row_mask:0xf bank_mask:0x3
    v_add_f32_dpp v21, v24, v24 row_ror:8 row_mask:0xf bank_mask:0x3
    v_add_f32_dpp v20, v23, v23 row_ror:8 row_mask:0xf bank_mask:0xc
    v_add_f32_dpp v21, v25, v25 row_ror:8 row_mask:0xf bank_mask:0xc
    v_add_f32_dpp v18, v26, v26 row_half_mirror row_mask:0xf bank_mask:0x5
    v_add_f32_dpp v18, v27, v27 row_half_mirror row_mask:0xf bank_mask:0xa
    v_add_f32_dpp v19, v20, v20 row_half_mirror row_mask:0xf bank_mask:0x5
    v_add_f32_dpp v19, v21, v21 row_half_mirror row_mask:0xf bank_mask:0xa
    s_nop 0
    v_add_f32_dpp v18, v18, v18 quad_perm:[1,0,3,2] row_mask:0xf bank_mask:0xf
    v_add_f32_dpp v19, v19, v19 quad_perm:[1,0,3,2] row_mask:0xf bank_mask:0xf
    s_nop 0
    v_add_f32_dpp v18, v18, v18 quad_perm:[2,3,0,1] row_mask:0xf bank_mask:0xf
    v_add_f32_dpp v19, v19, v19 quad_perm:[2,3,0,1] row_mask:0xf bank_mask:0xf
    v_cvt_pk_bf16_f32 v18, v18, v19
    v_lshlrev_b32 v20, 16, v18
    v_and_b32 v21, s86, v18
    v_mul_f32 v20, s84, v20
    v_mul_f32 v21, s84, v21
    v_cvt_pk_bf16_f32 v18, v20, v21
    s_cmp_ge_u32 s43, 2097152
    s_cbranch_scc1 L_pub2
    v_add_u32 v26, s43, v28
    ds_write_b32 v26, v18
    s_branch L_pe2
L_pub2:
    v_mov_b32 v29, v18
L_pe2:
L_A3:
    s_cmp_eq_u32 s77, 0
    s_cbranch_scc1 L_need0L_ha3
L_ha3:
    s_sub_u32 s77, s77, 1
    s_lshr_b32 s76, s57, 2
    s_lshl_b32 s76, s76, 16
    s_and_b32 s92, s57, 1
    s_lshl_b32 s92, s92, 12
    s_add_u32 s76, s76, s92
    s_and_b32 s92, s57, 2
    s_lshl_b32 s92, s92, 13
    s_add_u32 s76, s76, s92
    s_add_u32 s76, s76, s54
    s_lshr_b32 s42, s57, 1
    s_lshl_b32 s42, s42, 8
    s_lshr_b32 s92, s54, 6
    s_add_u32 s42, s42, s92
    s_and_b32 s92, s57, 1
    s_lshl_b32 s92, s92, 0
    s_and_b32 s92, s92, 4
    s_add_u32 s42, s42, s92
    s_add_u32 s42, s42, s34
    s_add_u32 s57, s57, 1
L_ha3_go:
    s_waitcnt vmcnt(24)
    v_dot2_f32_bf16 v18, v128, v4, 0
    v_dot2_f32_bf16 v19, v132, v4, 0
    v_dot2_f32_bf16 v20, v136, v4, 0
    v_dot2_f32_bf16 v21, v140, v4, 0
    v_dot2_f32_bf16 v22, v144, v4, 0
    v_dot2_f32_bf16 v23, v148, v4, 0
    v_dot2_f32_bf16 v24, v152, v4, 0
    v_dot2_f32_bf16 v25, v156, v4, 0
    v_dot2c_f32_bf16 v18, v129, v5
    v_dot2c_f32_bf16 v19, v133, v5
    v_dot2c_f32_bf16 v20, v137, v5
    v_dot2c_f32_bf16 v21, v141, v5
    v_dot2c_f32_bf16 v22, v145, v5
    v_dot2c_f32_bf16 v23, v149, v5
    v_dot2c_f32_bf16 v24, v153, v5
    v_dot2c_f32_bf16 v25, v157, v5
    v_dot2c_f32_bf16 v18, v130, v6
    v_dot2c_f32_bf16 v19, v134, v6
    v_dot2c_f32_bf16 v20, v138, v6
    v_dot2c_f32_bf16 v21, v142, v6
    v_dot2c_f32_bf16 v22, v146, v6
    v_dot2c_f32_bf16 v23, v150, v6
    v_dot2c_f32_bf16 v24, v154, v6
    v_dot2c_f32_bf16 v25, v158, v6
    v_dot2c_f32_bf16 v18, v131, v7
    v_dot2c_f32_bf16 v19, v135, v7
    v_dot2c_f32_bf16 v20, v139, v7
    v_dot2c_f32_bf16 v21, v143, v7
    v_dot2c_f32_bf16 v22, v147, v7
    v_dot2c_f32_bf16 v23, v151, v7
    v_dot2c_f32_bf16 v24, v155, v7
    v_dot2c_f32_bf16 v25, v159, v7
    s_mov_b32 s43, s13
    s_mov_b32 s13, s42
    buffer_load_dwordx4 v[128:131], v2, s[28:31], s76 offen offset:0 nt
    buffer_load_dwordx4 v[132:135], v2, s[28:31], s76 offen offset:512 nt
    buffer_load_dwordx4 v[136:139], v2, s[28:31], s76 offen offset:1024 nt
    buffer_load_dwordx4 v[140:143], v2, s[28:31], s76 offen offset:1536 nt
    buffer_load_dwordx4 v[144:147], v2, s[28:31], s76 offen offset:2048 nt
    buffer_load_dwordx4 v[148:151], v2, s[28:31], s76 offen offset:2560 nt
    buffer_load_dwordx4 v[152:155], v2, s[28:31], s76 offen offset:3072 nt
    buffer_load_dwordx4 v[156:159], v2, s[28:31], s76 offen offset:3584 nt
    v_add_f32_dpp v26, v18, v18 row_ror:8 row_mask:0xf bank_mask:0x3
    v_add_f32_dpp v27, v20, v20 row_ror:8 row_mask:0xf bank_mask:0x3
    v_add_f32_dpp v26, v19, v19 row_ror:8 row_mask:0xf bank_mask:0xc
    v_add_f32_dpp v27, v21, v21 row_ror:8 row_mask:0xf bank_mask:0xc
    v_add_f32_dpp v20, v22, v22 row_ror:8 row_mask:0xf bank_mask:0x3
    v_add_f32_dpp v21, v24, v24 row_ror:8 row_mask:0xf bank_mask:0x3
    v_add_f32_dpp v20, v23, v23 row_ror:8 row_mask:0xf bank_mask:0xc
    v_add_f32_dpp v21, v25, v25 row_ror:8 row_mask:0xf bank_mask:0xc
    v_add_f32_dpp v18, v26, v26 row_half_mirror row_mask:0xf bank_mask:0x5
    v_add_f32_dpp v18, v27, v27 row_half_mirror row_mask:0xf bank_mask:0xa
    v_add_f32_dpp v19, v20, v20 row_half_mirror row_mask:0xf bank_mask:0x5
    v_add_f32_dpp v19, v21, v21 row_half_mirror row_mask:0xf bank_mask:0xa
    s_nop 0
    v_add_f32_dpp v18, v18, v18 quad_perm:[1,0,3,2] row_mask:0xf bank_mask:0xf
    v_add_f32_dpp v19, v19, v19 quad_perm:[1,0,3,2] row_mask:0xf bank_mask:0xf
    s_nop 0
    v_add_f32_dpp v18, v18, v18 quad_perm:[2,3,0,1] row_mask:0xf bank_mask:0xf
    v_add_f32_dpp v19, v19, v19 quad_perm:[2,3,0,1] row_mask:0xf bank_mask:0xf
    v_cvt_pk_bf16_f32 v18, v18, v19
    v_lshlrev_b32 v20, 16, v18
    v_and_b32 v21, s86, v18
    v_mul_f32 v20, s84, v20
    v_mul_f32 v21, s84, v21
    v_cvt_pk_bf16_f32 v18, v20, v21
    s_cmp_ge_u32 s43, 2097152
    s_cbranch_scc1 L_pub3
    v_add_u32 v26, s43, v28
    ds_write_b32 v26, v18
    s_branch L_pe3
L_pub3:
    v_cndmask_b32 v18, v29, v18, s[80:81]
    ds_bpermute_b32 v19, v30, v18
    s_mov_b64 exec, 0xffffffff
    s_waitcnt lgkmcnt(0)
    buffer_store_dword v19, v31, s[44:47], s43 offen sc1
    s_mov_b64 exec, -1
L_pe3:
    s_branch L_A0
L_B0:
    s_cmp_eq_u32 s77, 0
    s_cbranch_scc1 L_need1L_hb0
L_hb0:
    s_sub_u32 s77, s77, 1
    s_lshr_b32 s76, s57, 2
    s_lshl_b32 s76, s76, 16
    s_and_b32 s92, s57, 1
    s_lshl_b32 s92, s92, 12
    s_add_u32 s76, s76, s92
    s_and_b32 s92, s57, 2
    s_lshl_b32 s92, s92, 13
    s_add_u32 s76, s76, s92
    s_add_u32 s76, s76, s54
    s_lshr_b32 s42, s57, 1
    s_lshl_b32 s42, s42, 8
    s_lshr_b32 s92, s54, 6
    s_add_u32 s42, s42, s92
    s_and_b32 s92, s57, 1
    s_lshl_b32 s92, s92, 2
    s_and_b32 s92, s92, 4
    s_add_u32 s42, s42, s92
    s_add_u32 s42, s42, s34
    s_add_u32 s57, s57, 1
L_hb0_go:
    s_waitcnt vmcnt(24)
    v_dot2_f32_bf16 v18, v32, v4, 0
    v_dot2_f32_bf16 v19, v36, v4, 0
    v_dot2_f32_bf16 v20, v40, v4, 0
    v_dot2_f32_bf16 v21, v44, v4, 0
    v_dot2_f32_bf16 v22, v48, v4, 0
    v_dot2_f32_bf16 v23, v52, v4, 0
    v_dot2_f32_bf16 v24, v56, v4, 0
    v_dot2_f32_bf16 v25, v60, v4, 0
    v_dot2c_f32_bf16 v18, v33, v5
    v_dot2c_f32_bf16 v19, v37, v5
    v_dot2c_f32_bf16 v20, v41, v5
    v_dot2c_f32_bf16 v21, v45, v5
    v_dot2c_f32_bf16 v22, v49, v5
    v_dot2c_f32_bf16 v23, v53, v5
    v_dot2c_f32_bf16 v24, v57, v5
    v_dot2c_f32_bf16 v25, v61, v5
    v_dot2c_f32_bf16 v18, v34, v6
    v_dot2c_f32_bf16 v19, v38, v6
    v_dot2c_f32_bf16 v20, v42, v6
    v_dot2c_f32_bf16 v21, v46, v6
    v_dot2c_f32_bf16 v22, v50, v6
    v_dot2c_f32_bf16 v23, v54, v6
    v_dot2c_f32_bf16 v24, v58, v6
    v_dot2c_f32_bf16 v25, v62, v6
    v_dot2c_f32_bf16 v18, v35, v7
    v_dot2c_f32_bf16 v19, v39, v7
    v_dot2c_f32_bf16 v20, v43, v7
    v_dot2c_f32_bf16 v21, v47, v7
    v_dot2c_f32_bf16 v22, v51, v7
    v_dot2c_f32_bf16 v23, v55, v7
    v_dot2c_f32_bf16 v24, v59, v7
    v_dot2c_f32_bf16 v25, v63, v7
    s_mov_b32 s43, s10
    s_cmp_ge_u32 s42, 2097152
    s_cbranch_scc1 L_sf4
    v_add_u32 v26, s42, v28
    ds_read_b32 v160, v26
    s_branch L_sg4
L_sf4:
    buffer_load_dword v160, v3, s[44:47], s42 offen sc1
L_sg4:
    buffer_load_dwordx4 v[32:35], v2, s[28:31], s76 offen offset:0 nt
    buffer_load_dwordx4 v[36:39], v2, s[28:31], s76 offen offset:512 nt
    buffer_load_dwordx4 v[40:43], v2, s[28:31], s76 offen offset:1024 nt
    buffer_load_dwordx4 v[44:47], v2, s[28:31], s76 offen offset:1536 nt
    buffer_load_dwordx4 v[48:51], v2, s[28:31], s76 offen offset:2048 nt
    buffer_load_dwordx4 v[52:55], v2, s[28:31], s76 offen offset:2560 nt
    buffer_load_dwordx4 v[56:59], v2, s[28:31], s76 offen offset:3072 nt
    buffer_load_dwordx4 v[60:63], v2, s[28:31], s76 offen offset:3584 nt
    v_add_f32_dpp v26, v18, v18 row_ror:8 row_mask:0xf bank_mask:0x3
    v_add_f32_dpp v27, v20, v20 row_ror:8 row_mask:0xf bank_mask:0x3
    v_add_f32_dpp v26, v19, v19 row_ror:8 row_mask:0xf bank_mask:0xc
    v_add_f32_dpp v27, v21, v21 row_ror:8 row_mask:0xf bank_mask:0xc
    v_add_f32_dpp v20, v22, v22 row_ror:8 row_mask:0xf bank_mask:0x3
    v_add_f32_dpp v21, v24, v24 row_ror:8 row_mask:0xf bank_mask:0x3
    v_add_f32_dpp v20, v23, v23 row_ror:8 row_mask:0xf bank_mask:0xc
    v_add_f32_dpp v21, v25, v25 row_ror:8 row_mask:0xf bank_mask:0xc
    v_add_f32_dpp v18, v26, v26 row_half_mirror row_mask:0xf bank_mask:0x5
    v_add_f32_dpp v18, v27, v27 row_half_mirror row_mask:0xf bank_mask:0xa
    v_add_f32_dpp v19, v20, v20 row_half_mirror row_mask:0xf bank_mask:0x5
    v_add_f32_dpp v19, v21, v21 row_half_mirror row_mask:0xf bank_mask:0xa
    s_nop 0
    v_add_f32_dpp v18, v18, v18 quad_perm:[1,0,3,2] row_mask:0xf bank_mask:0xf
    v_add_f32_dpp v19, v19, v19 quad_perm:[1,0,3,2] row_mask:0xf bank_mask:0xf
    s_nop 0
    v_add_f32_dpp v18, v18, v18 quad_perm:[2,3,0,1] row_mask:0xf bank_mask:0xf
    v_add_f32_dpp v19, v19, v19 quad_perm:[2,3,0,1] row_mask:0xf bank_mask:0xf
    v_cvt_pk_bf16_f32 v18, v18, v19
    v_lshlrev_b32 v20, 16, v18
    v_and_b32 v21, s86, v18
    v_mul_f32 v20, s84, v20
    v_mul_f32 v21, s84, v21
    v_cvt_pk_bf16_f32 v18, v20, v21
    s_cmp_ge_u32 s43, 2097152
    s_cbranch_scc1 L_pub5
    v_add_u32 v26, s43, v28
    ds_write_b32 v26, v18
    s_branch L_pe5
L_pub5:
    v_mov_b32 v29, v18
L_pe5:
    s_sub_u32 s88, s88, 1
    s_cmp_eq_u32 s88, 0
    s_cbranch_scc1 L_C1
L_B1:
    s_cmp_eq_u32 s77, 0
    s_cbranch_scc1 L_need1L_hb1
L_hb1:
    s_sub_u32 s77, s77, 1
    s_lshr_b32 s76, s57, 2
    s_lshl_b32 s76, s76, 16
    s_and_b32 s92, s57, 1
    s_lshl_b32 s92, s92, 12
    s_add_u32 s76, s76, s92
    s_and_b32 s92, s57, 2
    s_lshl_b32 s92, s92, 13
    s_add_u32 s76, s76, s92
    s_add_u32 s76, s76, s54
    s_lshr_b32 s42, s57, 1
    s_lshl_b32 s42, s42, 8
    s_lshr_b32 s92, s54, 6
    s_add_u32 s42, s42, s92
    s_and_b32 s92, s57, 1
    s_lshl_b32 s92, s92, 2
    s_and_b32 s92, s92, 4
    s_add_u32 s42, s42, s92
    s_add_u32 s42, s42, s34
    s_add_u32 s57, s57, 1
L_hb1_go:
    s_waitcnt vmcnt(24)
    v_dot2_f32_bf16 v18, v64, v4, 0
    v_dot2_f32_bf16 v19, v68, v4, 0
    v_dot2_f32_bf16 v20, v72, v4, 0
    v_dot2_f32_bf16 v21, v76, v4, 0
    v_dot2_f32_bf16 v22, v80, v4, 0
    v_dot2_f32_bf16 v23, v84, v4, 0
    v_dot2_f32_bf16 v24, v88, v4, 0
    v_dot2_f32_bf16 v25, v92, v4, 0
    v_dot2c_f32_bf16 v18, v65, v5
    v_dot2c_f32_bf16 v19, v69, v5
    v_dot2c_f32_bf16 v20, v73, v5
    v_dot2c_f32_bf16 v21, v77, v5
    v_dot2c_f32_bf16 v22, v81, v5
    v_dot2c_f32_bf16 v23, v85, v5
    v_dot2c_f32_bf16 v24, v89, v5
    v_dot2c_f32_bf16 v25, v93, v5
    v_dot2c_f32_bf16 v18, v66, v6
    v_dot2c_f32_bf16 v19, v70, v6
    v_dot2c_f32_bf16 v20, v74, v6
    v_dot2c_f32_bf16 v21, v78, v6
    v_dot2c_f32_bf16 v22, v82, v6
    v_dot2c_f32_bf16 v23, v86, v6
    v_dot2c_f32_bf16 v24, v90, v6
    v_dot2c_f32_bf16 v25, v94, v6
    v_dot2c_f32_bf16 v18, v67, v7
    v_dot2c_f32_bf16 v19, v71, v7
    v_dot2c_f32_bf16 v20, v75, v7
    v_dot2c_f32_bf16 v21, v79, v7
    v_dot2c_f32_bf16 v22, v83, v7
    v_dot2c_f32_bf16 v23, v87, v7
    v_dot2c_f32_bf16 v24, v91, v7
    v_dot2c_f32_bf16 v25, v95, v7
    s_mov_b32 s43, s11
    s_cmp_ge_u32 s42, 2097152
    s_cbranch_scc1 L_sf6
    v_add_u32 v26, s42, v28
    ds_read_b32 v161, v26
    s_branch L_sg6
L_sf6:
    buffer_load_dword v161, v3, s[44:47], s42 offen sc1
L_sg6:
    buffer_load_dwordx4 v[64:67], v2, s[28:31], s76 offen offset:0 nt
    buffer_load_dwordx4 v[68:71], v2, s[28:31], s76 offen offset:512 nt
    buffer_load_dwordx4 v[72:75], v2, s[28:31], s76 offen offset:1024 nt
    buffer_load_dwordx4 v[76:79], v2, s[28:31], s76 offen offset:1536 nt
    buffer_load_dwordx4 v[80:83], v2, s[28:31], s76 offen offset:2048 nt
    buffer_load_dwordx4 v[84:87], v2, s[28:31], s76 offen offset:2560 nt
    buffer_load_dwordx4 v[88:91], v2, s[28:31], s76 offen offset:3072 nt
    buffer_load_dwordx4 v[92:95], v2, s[28:31], s76 offen offset:3584 nt
    v_add_f32_dpp v26, v18, v18 row_ror:8 row_mask:0xf bank_mask:0x3
    v_add_f32_dpp v27, v20, v20 row_ror:8 row_mask:0xf bank_mask:0x3
    v_add_f32_dpp v26, v19, v19 row_ror:8 row_mask:0xf bank_mask:0xc
    v_add_f32_dpp v27, v21, v21 row_ror:8 row_mask:0xf bank_mask:0xc
    v_add_f32_dpp v20, v22, v22 row_ror:8 row_mask:0xf bank_mask:0x3
    v_add_f32_dpp v21, v24, v24 row_ror:8 row_mask:0xf bank_mask:0x3
    v_add_f32_dpp v20, v23, v23 row_ror:8 row_mask:0xf bank_mask:0xc
    v_add_f32_dpp v21, v25, v25 row_ror:8 row_mask:0xf bank_mask:0xc
    v_add_f32_dpp v18, v26, v26 row_half_mirror row_mask:0xf bank_mask:0x5
    v_add_f32_dpp v18, v27, v27 row_half_mirror row_mask:0xf bank_mask:0xa
    v_add_f32_dpp v19, v20, v20 row_half_mirror row_mask:0xf bank_mask:0x5
    v_add_f32_dpp v19, v21, v21 row_half_mirror row_mask:0xf bank_mask:0xa
    s_nop 0
    v_add_f32_dpp v18, v18, v18 quad_perm:[1,0,3,2] row_mask:0xf bank_mask:0xf
    v_add_f32_dpp v19, v19, v19 quad_perm:[1,0,3,2] row_mask:0xf bank_mask:0xf
    s_nop 0
    v_add_f32_dpp v18, v18, v18 quad_perm:[2,3,0,1] row_mask:0xf bank_mask:0xf
    v_add_f32_dpp v19, v19, v19 quad_perm:[2,3,0,1] row_mask:0xf bank_mask:0xf
    v_cvt_pk_bf16_f32 v18, v18, v19
    v_lshlrev_b32 v20, 16, v18
    v_and_b32 v21, s86, v18
    v_mul_f32 v20, s84, v20
    v_mul_f32 v21, s84, v21
    v_cvt_pk_bf16_f32 v18, v20, v21
    s_cmp_ge_u32 s43, 2097152
    s_cbranch_scc1 L_pub7
    v_add_u32 v26, s43, v28
    ds_write_b32 v26, v18
    s_branch L_pe7
L_pub7:
    v_cndmask_b32 v18, v29, v18, s[80:81]
    ds_bpermute_b32 v19, v30, v18
    s_mov_b64 exec, 0xffffffff
    s_waitcnt lgkmcnt(0)
    buffer_store_dword v19, v31, s[44:47], s43 offen sc1
    s_mov_b64 exec, -1
L_pe7:
    s_sub_u32 s88, s88, 1
    s_cmp_eq_u32 s88, 0
    s_cbranch_scc1 L_C2
L_B2:
    s_cmp_eq_u32 s77, 0
    s_cbranch_scc1 L_need1L_hb2
L_hb2:
    s_sub_u32 s77, s77, 1
    s_lshr_b32 s76, s57, 2
    s_lshl_b32 s76, s76, 16
    s_and_b32 s92, s57, 1
    s_lshl_b32 s92, s92, 12
    s_add_u32 s76, s76, s92
    s_and_b32 s92, s57, 2
    s_lshl_b32 s92, s92, 13
    s_add_u32 s76, s76, s92
    s_add_u32 s76, s76, s54
    s_lshr_b32 s42, s57, 1
    s_lshl_b32 s42, s42, 8
    s_lshr_b32 s92, s54, 6
    s_add_u32 s42, s42, s92
    s_and_b32 s92, s57, 1
    s_lshl_b32 s92, s92, 2
    s_and_b32 s92, s92, 4
    s_add_u32 s42, s42, s92
    s_add_u32 s42, s42, s34
    s_add_u32 s57, s57, 1
L_hb2_go:
    s_waitcnt vmcnt(24)
    v_dot2_f32_bf16 v18, v96, v4, 0
    v_dot2_f32_bf16 v19, v100, v4, 0
    v_dot2_f32_bf16 v20, v104, v4, 0
    v_dot2_f32_bf16 v21, v108, v4, 0
    v_dot2_f32_bf16 v22, v112, v4, 0
    v_dot2_f32_bf16 v23, v116, v4, 0
    v_dot2_f32_bf16 v24, v120, v4, 0
    v_dot2_f32_bf16 v25, v124, v4, 0
    v_dot2c_f32_bf16 v18, v97, v5
    v_dot2c_f32_bf16 v19, v101, v5
    v_dot2c_f32_bf16 v20, v105, v5
    v_dot2c_f32_bf16 v21, v109, v5
    v_dot2c_f32_bf16 v22, v113, v5
    v_dot2c_f32_bf16 v23, v117, v5
    v_dot2c_f32_bf16 v24, v121, v5
    v_dot2c_f32_bf16 v25, v125, v5
    v_dot2c_f32_bf16 v18, v98, v6
    v_dot2c_f32_bf16 v19, v102, v6
    v_dot2c_f32_bf16 v20, v106, v6
    v_dot2c_f32_bf16 v21, v110, v6
    v_dot2c_f32_bf16 v22, v114, v6
    v_dot2c_f32_bf16 v23, v118, v6
    v_dot2c_f32_bf16 v24, v122, v6
    v_dot2c_f32_bf16 v25, v126, v6
    v_dot2c_f32_bf16 v18, v99, v7
    v_dot2c_f32_bf16 v19, v103, v7
    v_dot2c_f32_bf16 v20, v107, v7
    v_dot2c_f32_bf16 v21, v111, v7
    v_dot2c_f32_bf16 v22, v115, v7
    v_dot2c_f32_bf16 v23, v119, v7
    v_dot2c_f32_bf16 v24, v123, v7
    v_dot2c_f32_bf16 v25, v127, v7
    s_mov_b32 s43, s12
    s_cmp_ge_u32 s42, 2097152
    s_cbranch_scc1 L_sf8
    v_add_u32 v26, s42, v28
    ds_read_b32 v162, v26
    s_branch L_sg8
L_sf8:
    buffer_load_dword v162, v3, s[44:47], s42 offen sc1
L_sg8:
    buffer_load_dwordx4 v[96:99], v2, s[28:31], s76 offen offset:0 nt
    buffer_load_dwordx4 v[100:103], v2, s[28:31], s76 offen offset:512 nt
    buffer_load_dwordx4 v[104:107], v2, s[28:31], s76 offen offset:1024 nt
    buffer_load_dwordx4 v[108:111], v2, s[28:31], s76 offen offset:1536 nt
    buffer_load_dwordx4 v[112:115], v2, s[28:31], s76 offen offset:2048 nt
    buffer_load_dwordx4 v[116:119], v2, s[28:31], s76 offen offset:2560 nt
    buffer_load_dwordx4 v[120:123], v2, s[28:31], s76 offen offset:3072 nt
    buffer_load_dwordx4 v[124:127], v2, s[28:31], s76 offen offset:3584 nt
    v_add_f32_dpp v26, v18, v18 row_ror:8 row_mask:0xf bank_mask:0x3
    v_add_f32_dpp v27, v20, v20 row_ror:8 row_mask:0xf bank_mask:0x3
    v_add_f32_dpp v26, v19, v19 row_ror:8 row_mask:0xf bank_mask:0xc
    v_add_f32_dpp v27, v21, v21 row_ror:8 row_mask:0xf bank_mask:0xc
    v_add_f32_dpp v20, v22, v22 row_ror:8 row_mask:0xf bank_mask:0x3
    v_add_f32_dpp v21, v24, v24 row_ror:8 row_mask:0xf bank_mask:0x3
    v_add_f32_dpp v20, v23, v23 row_ror:8 row_mask:0xf bank_mask:0xc
    v_add_f32_dpp v21, v25, v25 row_ror:8 row_mask:0xf bank_mask:0xc
    v_add_f32_dpp v18, v26, v26 row_half_mirror row_mask:0xf bank_mask:0x5
    v_add_f32_dpp v18, v27, v27 row_half_mirror row_mask:0xf bank_mask:0xa
    v_add_f32_dpp v19, v20, v20 row_half_mirror row_mask:0xf bank_mask:0x5
    v_add_f32_dpp v19, v21, v21 row_half_mirror row_mask:0xf bank_mask:0xa
    s_nop 0
    v_add_f32_dpp v18, v18, v18 quad_perm:[1,0,3,2] row_mask:0xf bank_mask:0xf
    v_add_f32_dpp v19, v19, v19 quad_perm:[1,0,3,2] row_mask:0xf bank_mask:0xf
    s_nop 0
    v_add_f32_dpp v18, v18, v18 quad_perm:[2,3,0,1] row_mask:0xf bank_mask:0xf
    v_add_f32_dpp v19, v19, v19 quad_perm:[2,3,0,1] row_mask:0xf bank_mask:0xf
    v_cvt_pk_bf16_f32 v18, v18, v19
    v_lshlrev_b32 v20, 16, v18
    v_and_b32 v21, s86, v18
    v_mul_f32 v20, s84, v20
    v_mul_f32 v21, s84, v21
    v_cvt_pk_bf16_f32 v18, v20, v21
    s_cmp_ge_u32 s43, 2097152
    s_cbranch_scc1 L_pub9
    v_add_u32 v26, s43, v28
    ds_write_b32 v26, v18
    s_branch L_pe9
L_pub9:
    v_mov_b32 v29, v18
L_pe9:
    s_sub_u32 s88, s88, 1
    s_cmp_eq_u32 s88, 0
    s_cbranch_scc1 L_C3
L_B3:
    s_cmp_eq_u32 s77, 0
    s_cbranch_scc1 L_need1L_hb3
L_hb3:
    s_sub_u32 s77, s77, 1
    s_lshr_b32 s76, s57, 2
    s_lshl_b32 s76, s76, 16
    s_and_b32 s92, s57, 1
    s_lshl_b32 s92, s92, 12
    s_add_u32 s76, s76, s92
    s_and_b32 s92, s57, 2
    s_lshl_b32 s92, s92, 13
    s_add_u32 s76, s76, s92
    s_add_u32 s76, s76, s54
    s_lshr_b32 s42, s57, 1
    s_lshl_b32 s42, s42, 8
    s_lshr_b32 s92, s54, 6
    s_add_u32 s42, s42, s92
    s_and_b32 s92, s57, 1
    s_lshl_b32 s92, s92, 2
    s_and_b32 s92, s92, 4
    s_add_u32 s42, s42, s92
    s_add_u32 s42, s42, s34
    s_add_u32 s57, s57, 1
L_hb3_go:
    s_waitcnt vmcnt(24)
    v_dot2_f32_bf16 v18, v128, v4, 0
    v_dot2_f32_bf16 v19, v132, v4, 0
    v_dot2_f32_bf16 v20, v136, v4, 0
    v_dot2_f32_bf16 v21, v140, v4, 0
    v_dot2_f32_bf16 v22, v144, v4, 0
    v_dot2_f32_bf16 v23, v148, v4, 0
    v_dot2_f32_bf16 v24, v152, v4, 0
    v_dot2_f32_bf16 v25, v156, v4, 0
    v_dot2c_f32_bf16 v18, v129, v5
    v_dot2c_f32_bf16 v19, v133, v5
    v_dot2c_f32_bf16 v20, v137, v5
    v_dot2c_f32_bf16 v21, v141, v5
    v_dot2c_f32_bf16 v22, v145, v5
    v_dot2c_f32_bf16 v23, v149, v5
    v_dot2c_f32_bf16 v24, v153, v5
    v_dot2c_f32_bf16 v25, v157, v5
    v_dot2c_f32_bf16 v18, v130, v6
    v_dot2c_f32_bf16 v19, v134, v6
    v_dot2c_f32_bf16 v20, v138, v6
    v_dot2c_f32_bf16 v21, v142, v6
    v_dot2c_f32_bf16 v22, v146, v6
    v_dot2c_f32_bf16 v23, v150, v6
    v_dot2c_f32_bf16 v24, v154, v6
    v_dot2c_f32_bf16 v25, v158, v6
    v_dot2c_f32_bf16 v18, v131, v7
    v_dot2c_f32_bf16 v19, v135, v7
    v_dot2c_f32_bf16 v20, v139, v7
    v_dot2c_f32_bf16 v21, v143, v7
    v_dot2c_f32_bf16 v22, v147, v7
    v_dot2c_f32_bf16 v23, v151, v7
    v_dot2c_f32_bf16 v24, v155, v7
    v_dot2c_f32_bf16 v25, v159, v7
    s_mov_b32 s43, s13
    s_cmp_ge_u32 s42, 2097152
    s_cbranch_scc1 L_sf10
    v_add_u32 v26, s42, v28
    ds_read_b32 v163, v26
    s_branch L_sg10
L_sf10:
    buffer_load_dword v163, v3, s[44:47], s42 offen sc1
L_sg10:
    buffer_load_dwordx4 v[128:131], v2, s[28:31], s76 offen offset:0 nt
    buffer_load_dwordx4 v[132:135], v2, s[28:31], s76 offen offset:512 nt
    buffer_load_dwordx4 v[136:139], v2, s[28:31], s76 offen offset:1024 nt
    buffer_load_dwordx4 v[140:143], v2, s[28:31], s76 offen offset:1536 nt
    buffer_load_dwordx4 v[144:147], v2, s[28:31], s76 offen offset:2048 nt
    buffer_load_dwordx4 v[148:151], v2, s[28:31], s76 offen offset:2560 nt
    buffer_load_dwordx4 v[152:155], v2, s[28:31], s76 offen offset:3072 nt
    buffer_load_dwordx4 v[156:159], v2, s[28:31], s76 offen offset:3584 nt
    v_add_f32_dpp v26, v18, v18 row_ror:8 row_mask:0xf bank_mask:0x3
    v_add_f32_dpp v27, v20, v20 row_ror:8 row_mask:0xf bank_mask:0x3
    v_add_f32_dpp v26, v19, v19 row_ror:8 row_mask:0xf bank_mask:0xc
    v_add_f32_dpp v27, v21, v21 row_ror:8 row_mask:0xf bank_mask:0xc
    v_add_f32_dpp v20, v22, v22 row_ror:8 row_mask:0xf bank_mask:0x3
    v_add_f32_dpp v21, v24, v24 row_ror:8 row_mask:0xf bank_mask:0x3
    v_add_f32_dpp v20, v23, v23 row_ror:8 row_mask:0xf bank_mask:0xc
    v_add_f32_dpp v21, v25, v25 row_ror:8 row_mask:0xf bank_mask:0xc
    v_add_f32_dpp v18, v26, v26 row_half_mirror row_mask:0xf bank_mask:0x5
    v_add_f32_dpp v18, v27, v27 row_half_mirror row_mask:0xf bank_mask:0xa
    v_add_f32_dpp v19, v20, v20 row_half_mirror row_mask:0xf bank_mask:0x5
    v_add_f32_dpp v19, v21, v21 row_half_mirror row_mask:0xf bank_mask:0xa
    s_nop 0
    v_add_f32_dpp v18, v18, v18 quad_perm:[1,0,3,2] row_mask:0xf bank_mask:0xf
    v_add_f32_dpp v19, v19, v19 quad_perm:[1,0,3,2] row_mask:0xf bank_mask:0xf
    s_nop 0
    v_add_f32_dpp v18, v18, v18 quad_perm:[2,3,0,1] row_mask:0xf bank_mask:0xf
    v_add_f32_dpp v19, v19, v19 quad_perm:[2,3,0,1] row_mask:0xf bank_mask:0xf
    v_cvt_pk_bf16_f32 v18, v18, v19
    v_lshlrev_b32 v20, 16, v18
    v_and_b32 v21, s86, v18
    v_mul_f32 v20, s84, v20
    v_mul_f32 v21, s84, v21
    v_cvt_pk_bf16_f32 v18, v20, v21
    s_cmp_ge_u32 s43, 2097152
    s_cbranch_scc1 L_pub11
    v_add_u32 v26, s43, v28
    ds_write_b32 v26, v18
    s_branch L_pe11
L_pub11:
    v_cndmask_b32 v18, v29, v18, s[80:81]
    ds_bpermute_b32 v19, v30, v18
    s_mov_b64 exec, 0xffffffff
    s_waitcnt lgkmcnt(0)
    buffer_store_dword v19, v31, s[44:47], s43 offen sc1
    s_mov_b64 exec, -1
L_pe11:
    s_sub_u32 s88, s88, 1
    s_cmp_eq_u32 s88, 0
    s_cbranch_scc1 L_C0
    s_branch L_B0
L_C0:
    s_cmp_eq_u32 s77, 0
    s_cbranch_scc1 L_need1L_hc0
L_hc0:
    s_sub_u32 s77, s77, 1
    s_lshr_b32 s76, s57, 2
    s_lshl_b32 s76, s76, 16
    s_and_b32 s92, s57, 1
    s_lshl_b32 s92, s92, 12
    s_add_u32 s76, s76, s92
    s_and_b32 s92, s57, 2
    s_lshl_b32 s92, s92, 13
    s_add_u32 s76, s76, s92
    s_add_u32 s76, s76, s54
    s_lshr_b32 s42, s57, 1
    s_lshl_b32 s42, s42, 8
    s_lshr_b32 s92, s54, 6
    s_add_u32 s42, s42, s92
    s_and_b32 s92, s57, 1
    s_lshl_b32 s92, s92, 2
    s_and_b32 s92, s92, 4
    s_add_u32 s42, s42, s92
    s_add_u32 s42, s42, s34
    s_add_u32 s57, s57, 1
L_hc0_go:
    s_waitcnt vmcnt(24) lgkmcnt(0)
    v_lshlrev_b32 v20, 16, v160
    v_and_b32 v21, s86, v160
    v_max_f32 v22, v20, v21
    s_nop 1
    v_max_f32_dpp v22, v22, v22 row_ror:8 row_mask:0xf bank_mask:0xf
    s_nop 1
    v_max_f32_dpp v22, v22, v22 row_ror:4 row_mask:0xf bank_mask:0xf
    v_max_f32 v22, v16, v22
    v_sub_f32 v20, v20, v22
    v_sub_f32 v21, v21, v22
    v_sub_f32 v24, v16, v22
    v_mul_f32 v20, s85, v20
    v_mul_f32 v21, s85, v21
    v_mul_f32 v24, s85, v24
    v_exp_f32 v20, v20
    v_exp_f32 v21, v21
    v_exp_f32 v24, v24
    v_mov_b32 v16, v22
    v_cvt_pk_bf16_f32 v18, v20, 0
    v_cvt_pk_bf16_f32 v22, v21, 0
    v_fma_f32 v17, v17, v24, v20
    v_lshlrev_b32 v19, 16, v18
    v_lshlrev_b32 v23, 16, v22
    v_add_f32 v17, v17, v21
    v_pk_mul_f32 v[8:9], v[8:9], v[24:25] op_sel_hi:[1,0]
    v_pk_mul_f32 v[10:11], v[10:11], v[24:25] op_sel_hi:[1,0]
    v_pk_mul_f32 v[12:13], v[12:13], v[24:25] op_sel_hi:[1,0]
    v_pk_mul_f32 v[14:15], v[14:15], v[24:25] op_sel_hi:[1,0]
    v_dot2c_f32_bf16_dpp v8, v18, v32 row_newbcast:0 row_mask:0xf bank_mask:0xf
    v_dot2c_f32_bf16_dpp v9, v19, v32 row_newbcast:0 row_mask:0xf bank_mask:0xf
    v_dot2c_f32_bf16_dpp v10, v18, v33 row_newbcast:0 row_mask:0xf bank_mask:0xf
    v_dot2c_f32_bf16_dpp v11, v19, v33 row_newbcast:0 row_mask:0xf bank_mask:0xf
    v_dot2c_f32_bf16_dpp v12, v18, v34 row_newbcast:0 row_mask:0xf bank_mask:0xf
    v_dot2c_f32_bf16_dpp v13, v19, v34 row_newbcast:0 row_mask:0xf bank_mask:0xf
    v_dot2c_f32_bf16_dpp v14, v18, v35 row_newbcast:0 row_mask:0xf bank_mask:0xf
    v_dot2c_f32_bf16_dpp v15, v19, v35 row_newbcast:0 row_mask:0xf bank_mask:0xf
    v_dot2c_f32_bf16_dpp v8, v18, v36 row_newbcast:8 row_mask:0xf bank_mask:0xf
    v_dot2c_f32_bf16_dpp v9, v19, v36 row_newbcast:8 row_mask:0xf bank_mask:0xf
    v_dot2c_f32_bf16_dpp v10, v18, v37 row_newbcast:8 row_mask:0xf bank_mask:0xf
    v_dot2c_f32_bf16_dpp v11, v19, v37 row_newbcast:8 row_mask:0xf bank_mask:0xf
    v_dot2c_f32_bf16_dpp v12, v18, v38 row_newbcast:8 row_mask:0xf bank_mask:0xf
    v_dot2c_f32_bf16_dpp v13, v19, v38 row_newbcast:8 row_mask:0xf bank_mask:0xf
    v_dot2c_f32_bf16_dpp v14, v18, v39 row_newbcast:8 row_mask:0xf bank_mask:0xf
    v_dot2c_f32_bf16_dpp v15, v19, v39 row_newbcast:8 row_mask:0xf bank_mask:0xf
    v_dot2c_f32_bf16_dpp v8, v18, v40 row_newbcast:4 row_mask:0xf bank_mask:0xf
    v_dot2c_f32_bf16_dpp v9, v19, v40 row_newbcast:4 row_mask:0xf bank_mask:0xf
    v_dot2c_f32_bf16_dpp v10, v18, v41 row_newbcast:4 row_mask:0xf bank_mask:0xf
    v_dot2c_f32_bf16_dpp v11, v19, v41 row_newbcast:4 row_mask:0xf bank_mask:0xf
    v_dot2c_f32_bf16_dpp v12, v18, v42 row_newbcast:4 row_mask:0xf bank_mask:0xf
    v_dot2c_f32_bf16_dpp v13, v19, v42 row_newbcast:4 row_mask:0xf bank_mask:0xf
    v_dot2c_f32_bf16_dpp v14, v18, v43 row_newbcast:4 row_mask:0xf bank_mask:0xf
    v_dot2c_f32_bf16_dpp v15, v19, v43 row_newbcast:4 row_mask:0xf bank_mask:0xf
    v_dot2c_f32_bf16_dpp v8, v18, v44 row_newbcast:12 row_mask:0xf bank_mask:0xf
    v_dot2c_f32_bf16_dpp v9, v19, v44 row_newbcast:12 row_mask:0xf bank_mask:0xf
    v_dot2c_f32_bf16_dpp v10, v18, v45 row_newbcast:12 row_mask:0xf bank_mask:0xf
    v_dot2c_f32_bf16_dpp v11, v19, v45 row_newbcast:12 row_mask:0xf bank_mask:0xf
    v_dot2c_f32_bf16_dpp v12, v18, v46 row_newbcast:12 row_mask:0xf bank_mask:0xf
    v_dot2c_f32_bf16_dpp v13, v19, v46 row_newbcast:12 row_mask:0xf bank_mask:0xf
    v_dot2c_f32_bf16_dpp v14, v18, v47 row_newbcast:12 row_mask:0xf bank_mask:0xf
    v_dot2c_f32_bf16_dpp v15, v19, v47 row_newbcast:12 row_mask:0xf bank_mask:0xf
    v_dot2c_f32_bf16_dpp v8, v22, v48 row_newbcast:0 row_mask:0xf bank_mask:0xf
    v_dot2c_f32_bf16_dpp v9, v23, v48 row_newbcast:0 row_mask:0xf bank_mask:0xf
    v_dot2c_f32_bf16_dpp v10, v22, v49 row_newbcast:0 row_mask:0xf bank_mask:0xf
    v_dot2c_f32_bf16_dpp v11, v23, v49 row_newbcast:0 row_mask:0xf bank_mask:0xf
    v_dot2c_f32_bf16_dpp v12, v22, v50 row_newbcast:0 row_mask:0xf bank_mask:0xf
    v_dot2c_f32_bf16_dpp v13, v23, v50 row_newbcast:0 row_mask:0xf bank_mask:0xf
    v_dot2c_f32_bf16_dpp v14, v22, v51 row_newbcast:0 row_mask:0xf bank_mask:0xf
    v_dot2c_f32_bf16_dpp v15, v23, v51 row_newbcast:0 row_mask:0xf bank_mask:0xf
    v_dot2c_f32_bf16_dpp v8, v22, v52 row_newbcast:8 row_mask:0xf bank_mask:0xf
    v_dot2c_f32_bf16_dpp v9, v23, v52 row_newbcast:8 row_mask:0xf bank_mask:0xf
    v_dot2c_f32_bf16_dpp v10, v22, v53 row_newbcast:8 row_mask:0xf bank_mask:0xf
    v_dot2c_f32_bf16_dpp v11, v23, v53 row_newbcast:8 row_mask:0xf bank_mask:0xf
    v_dot2c_f32_bf16_dpp v12, v22, v54 row_newbcast:8 row_mask:0xf bank_mask:0xf
    v_dot2c_f32_bf16_dpp v13, v23, v54 row_newbcast:8 row_mask:0xf bank_mask:0xf
    v_dot2c_f32_bf16_dpp v14, v22, v55 row_newbcast:8 row_mask:0xf bank_mask:0xf
    v_dot2c_f32_bf16_dpp v15, v23, v55 row_newbcast:8 row_mask:0xf bank_mask:0xf
    v_dot2c_f32_bf16_dpp v8, v22, v56 row_newbcast:4 row_mask:0xf bank_mask:0xf
    v_dot2c_f32_bf16_dpp v9, v23, v56 row_newbcast:4 row_mask:0xf bank_mask:0xf
    v_dot2c_f32_bf16_dpp v10, v22, v57 row_newbcast:4 row_mask:0xf bank_mask:0xf
    v_dot2c_f32_bf16_dpp v11, v23, v57 row_newbcast:4 row_mask:0xf bank_mask:0xf
    v_dot2c_f32_bf16_dpp v12, v22, v58 row_newbcast:4 row_mask:0xf bank_mask:0xf
    v_dot2c_f32_bf16_dpp v13, v23, v58 row_newbcast:4 row_mask:0xf bank_mask:0xf
    v_dot2c_f32_bf16_dpp v14, v22, v59 row_newbcast:4 row_mask:0xf bank_mask:0xf
    v_dot2c_f32_bf16_dpp v15, v23, v59 row_newbcast:4 row_mask:0xf bank_mask:0xf
    v_dot2c_f32_bf16_dpp v8, v22, v60 row_newbcast:12 row_mask:0xf bank_mask:0xf
    v_dot2c_f32_bf16_dpp v9, v23, v60 row_newbcast:12 row_mask:0xf bank_mask:0xf
    v_dot2c_f32_bf16_dpp v10, v22, v61 row_newbcast:12 row_mask:0xf bank_mask:0xf
    v_dot2c_f32_bf16_dpp v11, v23, v61 row_newbcast:12 row_mask:0xf bank_mask:0xf
    v_dot2c_f32_bf16_dpp v12, v22, v62 row_newbcast:12 row_mask:0xf bank_mask:0xf
    v_dot2c_f32_bf16_dpp v13, v23, v62 row_newbcast:12 row_mask:0xf bank_mask:0xf
    v_dot2c_f32_bf16_dpp v14, v22, v63 row_newbcast:12 row_mask:0xf bank_mask:0xf
    v_dot2c_f32_bf16_dpp v15, v23, v63 row_newbcast:12 row_mask:0xf bank_mask:0xf
    s_cmp_ge_u32 s42, 2097152
    s_cbranch_scc1 L_sf12
    v_add_u32 v26, s42, v28
    ds_read_b32 v160, v26
    s_branch L_sg12
L_sf12:
    buffer_load_dword v160, v3, s[44:47], s42 offen sc1
L_sg12:
    buffer_load_dwordx4 v[32:35], v2, s[28:31], s76 offen offset:0 nt
    buffer_load_dwordx4 v[36:39], v2, s[28:31], s76 offen offset:512 nt
    buffer_load_dwordx4 v[40:43], v2, s[28:31], s76 offen offset:1024 nt
    buffer_load_dwordx4 v[44:47], v2, s[28:31], s76 offen offset:1536 nt
    buffer_load_dwordx4 v[48:51], v2, s[28:31], s76 offen offset:2048 nt
    buffer_load_dwordx4 v[52:55], v2, s[28:31], s76 offen offset:2560 nt
    buffer_load_dwordx4 v[56:59], v2, s[28:31], s76 offen offset:3072 nt
    buffer_load_dwordx4 v[60:63], v2, s[28:31], s76 offen offset:3584 nt
L_C1:
    s_cmp_eq_u32 s77, 0
    s_cbranch_scc1 L_need1L_hc1
L_hc1:
    s_sub_u32 s77, s77, 1
    s_lshr_b32 s76, s57, 2
    s_lshl_b32 s76, s76, 16
    s_and_b32 s92, s57, 1
    s_lshl_b32 s92, s92, 12
    s_add_u32 s76, s76, s92
    s_and_b32 s92, s57, 2
    s_lshl_b32 s92, s92, 13
    s_add_u32 s76, s76, s92
    s_add_u32 s76, s76, s54
    s_lshr_b32 s42, s57, 1
    s_lshl_b32 s42, s42, 8
    s_lshr_b32 s92, s54, 6
    s_add_u32 s42, s42, s92
    s_and_b32 s92, s57, 1
    s_lshl_b32 s92, s92, 2
    s_and_b32 s92, s92, 4
    s_add_u32 s42, s42, s92
    s_add_u32 s42, s42, s34
    s_add_u32 s57, s57, 1
L_hc1_go:
    s_waitcnt vmcnt(24) lgkmcnt(0)
    v_lshlrev_b32 v20, 16, v161
    v_and_b32 v21, s86, v161
    v_max_f32 v22, v20, v21
    s_nop 1
    v_max_f32_dpp v22, v22, v22 row_ror:8 row_mask:0xf bank_mask:0xf
    s_nop 1
    v_max_f32_dpp v22, v22, v22 row_ror:4 row_mask:0xf bank_mask:0xf
    v_max_f32 v22, v16, v22
    v_sub_f32 v20, v20, v22
    v_sub_f32 v21, v21, v22
    v_sub_f32 v24, v16, v22
    v_mul_f32 v20, s85, v20
    v_mul_f32 v21, s85, v21
    v_mul_f32 v24, s85, v24
    v_exp_f32 v20, v20
    v_exp_f32 v21, v21
    v_exp_f32 v24, v24
    v_mov_b32 v16, v22
    v_cvt_pk_bf16_f32 v18, v20, 0
    v_cvt_pk_bf16_f32 v22, v21, 0
    v_fma_f32 v17, v17, v24, v20
    v_lshlrev_b32 v19, 16, v18
    v_lshlrev_b32 v23, 16, v22
    v_add_f32 v17, v17, v21
    v_pk_mul_f32 v[8:9], v[8:9], v[24:25] op_sel_hi:[1,0]
    v_pk_mul_f32 v[10:11], v[10:11], v[24:25] op_sel_hi:[1,0]
    v_pk_mul_f32 v[12:13], v[12:13], v[24:25] op_sel_hi:[1,0]
    v_pk_mul_f32 v[14:15], v[14:15], v[24:25] op_sel_hi:[1,0]
    v_dot2c_f32_bf16_dpp v8, v18, v64 row_newbcast:0 row_mask:0xf bank_mask:0xf
    v_dot2c_f32_bf16_dpp v9, v19, v64 row_newbcast:0 row_mask:0xf bank_mask:0xf
    v_dot2c_f32_bf16_dpp v10, v18, v65 row_newbcast:0 row_mask:0xf bank_mask:0xf
    v_dot2c_f32_bf16_dpp v11, v19, v65 row_newbcast:0 row_mask:0xf bank_mask:0xf
    v_dot2c_f32_bf16_dpp v12, v18, v66 row_newbcast:0 row_mask:0xf bank_mask:0xf
    v_dot2c_f32_bf16_dpp v13, v19, v66 row_newbcast:0 row_mask:0xf bank_mask:0xf
    v_dot2c_f32_bf16_dpp v14, v18, v67 row_newbcast:0 row_mask:0xf bank_mask:0xf
    v_dot2c_f32_bf16_dpp v15, v19, v67 row_newbcast:0 row_mask:0xf bank_mask:0xf
    v_dot2c_f32_bf16_dpp v8, v18, v68 row_newbcast:8 row_mask:0xf bank_mask:0xf
    v_dot2c_f32_bf16_dpp v9, v19, v68 row_newbcast:8 row_mask:0xf bank_mask:0xf
    v_dot2c_f32_bf16_dpp v10, v18, v69 row_newbcast:8 row_mask:0xf bank_mask:0xf
    v_dot2c_f32_bf16_dpp v11, v19, v69 row_newbcast:8 row_mask:0xf bank_mask:0xf
    v_dot2c_f32_bf16_dpp v12, v18, v70 row_newbcast:8 row_mask:0xf bank_mask:0xf
    v_dot2c_f32_bf16_dpp v13, v19, v70 row_newbcast:8 row_mask:0xf bank_mask:0xf
    v_dot2c_f32_bf16_dpp v14, v18, v71 row_newbcast:8 row_mask:0xf bank_mask:0xf
    v_dot2c_f32_bf16_dpp v15, v19, v71 row_newbcast:8 row_mask:0xf bank_mask:0xf
    v_dot2c_f32_bf16_dpp v8, v18, v72 row_newbcast:4 row_mask:0xf bank_mask:0xf
    v_dot2c_f32_bf16_dpp v9, v19, v72 row_newbcast:4 row_mask:0xf bank_mask:0xf
    v_dot2c_f32_bf16_dpp v10, v18, v73 row_newbcast:4 row_mask:0xf bank_mask:0xf
    v_dot2c_f32_bf16_dpp v11, v19, v73 row_newbcast:4 row_mask:0xf bank_mask:0xf
    v_dot2c_f32_bf16_dpp v12, v18, v74 row_newbcast:4 row_mask:0xf bank_mask:0xf
    v_dot2c_f32_bf16_dpp v13, v19, v74 row_newbcast:4 row_mask:0xf bank_mask:0xf
    v_dot2c_f32_bf16_dpp v14, v18, v75 row_newbcast:4 row_mask:0xf bank_mask:0xf
    v_dot2c_f32_bf16_dpp v15, v19, v75 row_newbcast:4 row_mask:0xf bank_mask:0xf
    v_dot2c_f32_bf16_dpp v8, v18, v76 row_newbcast:12 row_mask:0xf bank_mask:0xf
    v_dot2c_f32_bf16_dpp v9, v19, v76 row_newbcast:12 row_mask:0xf bank_mask:0xf
    v_dot2c_f32_bf16_dpp v10, v18, v77 row_newbcast:12 row_mask:0xf bank_mask:0xf
    v_dot2c_f32_bf16_dpp v11, v19, v77 row_newbcast:12 row_mask:0xf bank_mask:0xf
    v_dot2c_f32_bf16_dpp v12, v18, v78 row_newbcast:12 row_mask:0xf bank_mask:0xf
    v_dot2c_f32_bf16_dpp v13, v19, v78 row_newbcast:12 row_mask:0xf bank_mask:0xf
    v_dot2c_f32_bf16_dpp v14, v18, v79 row_newbcast:12 row_mask:0xf bank_mask:0xf
    v_dot2c_f32_bf16_dpp v15, v19, v79 row_newbcast:12 row_mask:0xf bank_mask:0xf
    v_dot2c_f32_bf16_dpp v8, v22, v80 row_newbcast:0 row_mask:0xf bank_mask:0xf
    v_dot2c_f32_bf16_dpp v9, v23, v80 row_newbcast:0 row_mask:0xf bank_mask:0xf
    v_dot2c_f32_bf16_dpp v10, v22, v81 row_newbcast:0 row_mask:0xf bank_mask:0xf
    v_dot2c_f32_bf16_dpp v11, v23, v81 row_newbcast:0 row_mask:0xf bank_mask:0xf
    v_dot2c_f32_bf16_dpp v12, v22, v82 row_newbcast:0 row_mask:0xf bank_mask:0xf
    v_dot2c_f32_bf16_dpp v13, v23, v82 row_newbcast:0 row_mask:0xf bank_mask:0xf
    v_dot2c_f32_bf16_dpp v14, v22, v83 row_newbcast:0 row_mask:0xf bank_mask:0xf
    v_dot2c_f32_bf16_dpp v15, v23, v83 row_newbcast:0 row_mask:0xf bank_mask:0xf
    v_dot2c_f32_bf16_dpp v8, v22, v84 row_newbcast:8 row_mask:0xf bank_mask:0xf
    v_dot2c_f32_bf16_dpp v9, v23, v84 row_newbcast:8 row_mask:0xf bank_mask:0xf
    v_dot2c_f32_bf16_dpp v10, v22, v85 row_newbcast:8 row_mask:0xf bank_mask:0xf
    v_dot2c_f32_bf16_dpp v11, v23, v85 row_newbcast:8 row_mask:0xf bank_mask:0xf
    v_dot2c_f32_bf16_dpp v12, v22, v86 row_newbcast:8 row_mask:0xf bank_mask:0xf
    v_dot2c_f32_bf16_dpp v13, v23, v86 row_newbcast:8 row_mask:0xf bank_mask:0xf
    v_dot2c_f32_bf16_dpp v14, v22, v87 row_newbcast:8 row_mask:0xf bank_mask:0xf
    v_dot2c_f32_bf16_dpp v15, v23, v87 row_newbcast:8 row_mask:0xf bank_mask:0xf
    v_dot2c_f32_bf16_dpp v8, v22, v88 row_newbcast:4 row_mask:0xf bank_mask:0xf
    v_dot2c_f32_bf16_dpp v9, v23, v88 row_newbcast:4 row_mask:0xf bank_mask:0xf
    v_dot2c_f32_bf16_dpp v10, v22, v89 row_newbcast:4 row_mask:0xf bank_mask:0xf
    v_dot2c_f32_bf16_dpp v11, v23, v89 row_newbcast:4 row_mask:0xf bank_mask:0xf
    v_dot2c_f32_bf16_dpp v12, v22, v90 row_newbcast:4 row_mask:0xf bank_mask:0xf
    v_dot2c_f32_bf16_dpp v13, v23, v90 row_newbcast:4 row_mask:0xf bank_mask:0xf
    v_dot2c_f32_bf16_dpp v14, v22, v91 row_newbcast:4 row_mask:0xf bank_mask:0xf
    v_dot2c_f32_bf16_dpp v15, v23, v91 row_newbcast:4 row_mask:0xf bank_mask:0xf
    v_dot2c_f32_bf16_dpp v8, v22, v92 row_newbcast:12 row_mask:0xf bank_mask:0xf
    v_dot2c_f32_bf16_dpp v9, v23, v92 row_newbcast:12 row_mask:0xf bank_mask:0xf
    v_dot2c_f32_bf16_dpp v10, v22, v93 row_newbcast:12 row_mask:0xf bank_mask:0xf
    v_dot2c_f32_bf16_dpp v11, v23, v93 row_newbcast:12 row_mask:0xf bank_mask:0xf
    v_dot2c_f32_bf16_dpp v12, v22, v94 row_newbcast:12 row_mask:0xf bank_mask:0xf
    v_dot2c_f32_bf16_dpp v13, v23, v94 row_newbcast:12 row_mask:0xf bank_mask:0xf
    v_dot2c_f32_bf16_dpp v14, v22, v95 row_newbcast:12 row_mask:0xf bank_mask:0xf
    v_dot2c_f32_bf16_dpp v15, v23, v95 row_newbcast:12 row_mask:0xf bank_mask:0xf
    s_cmp_ge_u32 s42, 2097152
    s_cbranch_scc1 L_sf13
    v_add_u32 v26, s42, v28
    ds_read_b32 v161, v26
    s_branch L_sg13
L_sf13:
    buffer_load_dword v161, v3, s[44:47], s42 offen sc1
L_sg13:
    buffer_load_dwordx4 v[64:67], v2, s[28:31], s76 offen offset:0 nt
    buffer_load_dwordx4 v[68:71], v2, s[28:31], s76 offen offset:512 nt
    buffer_load_dwordx4 v[72:75], v2, s[28:31], s76 offen offset:1024 nt
    buffer_load_dwordx4 v[76:79], v2, s[28:31], s76 offen offset:1536 nt
    buffer_load_dwordx4 v[80:83], v2, s[28:31], s76 offen offset:2048 nt
    buffer_load_dwordx4 v[84:87], v2, s[28:31], s76 offen offset:2560 nt
    buffer_load_dwordx4 v[88:91], v2, s[28:31], s76 offen offset:3072 nt
    buffer_load_dwordx4 v[92:95], v2, s[28:31], s76 offen offset:3584 nt
L_C2:
    s_cmp_eq_u32 s77, 0
    s_cbranch_scc1 L_need1L_hc2
L_hc2:
    s_sub_u32 s77, s77, 1
    s_lshr_b32 s76, s57, 2
    s_lshl_b32 s76, s76, 16
    s_and_b32 s92, s57, 1
    s_lshl_b32 s92, s92, 12
    s_add_u32 s76, s76, s92
    s_and_b32 s92, s57, 2
    s_lshl_b32 s92, s92, 13
    s_add_u32 s76, s76, s92
    s_add_u32 s76, s76, s54
    s_lshr_b32 s42, s57, 1
    s_lshl_b32 s42, s42, 8
    s_lshr_b32 s92, s54, 6
    s_add_u32 s42, s42, s92
    s_and_b32 s92, s57, 1
    s_lshl_b32 s92, s92, 2
    s_and_b32 s92, s92, 4
    s_add_u32 s42, s42, s92
    s_add_u32 s42, s42, s34
    s_add_u32 s57, s57, 1
L_hc2_go:
    s_waitcnt vmcnt(24) lgkmcnt(0)
    v_lshlrev_b32 v20, 16, v162
    v_and_b32 v21, s86, v162
    v_max_f32 v22, v20, v21
    s_nop 1
    v_max_f32_dpp v22, v22, v22 row_ror:8 row_mask:0xf bank_mask:0xf
    s_nop 1
    v_max_f32_dpp v22, v22, v22 row_ror:4 row_mask:0xf bank_mask:0xf
    v_max_f32 v22, v16, v22
    v_sub_f32 v20, v20, v22
    v_sub_f32 v21, v21, v22
    v_sub_f32 v24, v16, v22
    v_mul_f32 v20, s85, v20
    v_mul_f32 v21, s85, v21
    v_mul_f32 v24, s85, v24
    v_exp_f32 v20, v20
    v_exp_f32 v21, v21
    v_exp_f32 v24, v24
    v_mov_b32 v16, v22
    v_cvt_pk_bf16_f32 v18, v20, 0
    v_cvt_pk_bf16_f32 v22, v21, 0
    v_fma_f32 v17, v17, v24, v20
    v_lshlrev_b32 v19, 16, v18
    v_lshlrev_b32 v23, 16, v22
    v_add_f32 v17, v17, v21
    v_pk_mul_f32 v[8:9], v[8:9], v[24:25] op_sel_hi:[1,0]
    v_pk_mul_f32 v[10:11], v[10:11], v[24:25] op_sel_hi:[1,0]
    v_pk_mul_f32 v[12:13], v[12:13], v[24:25] op_sel_hi:[1,0]
    v_pk_mul_f32 v[14:15], v[14:15], v[24:25] op_sel_hi:[1,0]
    v_dot2c_f32_bf16_dpp v8, v18, v96 row_newbcast:0 row_mask:0xf bank_mask:0xf
    v_dot2c_f32_bf16_dpp v9, v19, v96 row_newbcast:0 row_mask:0xf bank_mask:0xf
    v_dot2c_f32_bf16_dpp v10, v18, v97 row_newbcast:0 row_mask:0xf bank_mask:0xf
    v_dot2c_f32_bf16_dpp v11, v19, v97 row_newbcast:0 row_mask:0xf bank_mask:0xf
    v_dot2c_f32_bf16_dpp v12, v18, v98 row_newbcast:0 row_mask:0xf bank_mask:0xf
    v_dot2c_f32_bf16_dpp v13, v19, v98 row_newbcast:0 row_mask:0xf bank_mask:0xf
    v_dot2c_f32_bf16_dpp v14, v18, v99 row_newbcast:0 row_mask:0xf bank_mask:0xf
    v_dot2c_f32_bf16_dpp v15, v19, v99 row_newbcast:0 row_mask:0xf bank_mask:0xf
    v_dot2c_f32_bf16_dpp v8, v18, v100 row_newbcast:8 row_mask:0xf bank_mask:0xf
    v_dot2c_f32_bf16_dpp v9, v19, v100 row_newbcast:8 row_mask:0xf bank_mask:0xf
    v_dot2c_f32_bf16_dpp v10, v18, v101 row_newbcast:8 row_mask:0xf bank_mask:0xf
    v_dot2c_f32_bf16_dpp v11, v19, v101 row_newbcast:8 row_mask:0xf bank_mask:0xf
    v_dot2c_f32_bf16_dpp v12, v18, v102 row_newbcast:8 row_mask:0xf bank_mask:0xf
    v_dot2c_f32_bf16_dpp v13, v19, v102 row_newbcast:8 row_mask:0xf bank_mask:0xf
    v_dot2c_f32_bf16_dpp v14, v18, v103 row_newbcast:8 row_mask:0xf bank_mask:0xf
    v_dot2c_f32_bf16_dpp v15, v19, v103 row_newbcast:8 row_mask:0xf bank_mask:0xf
    v_dot2c_f32_bf16_dpp v8, v18, v104 row_newbcast:4 row_mask:0xf bank_mask:0xf
    v_dot2c_f32_bf16_dpp v9, v19, v104 row_newbcast:4 row_mask:0xf bank_mask:0xf
    v_dot2c_f32_bf16_dpp v10, v18, v105 row_newbcast:4 row_mask:0xf bank_mask:0xf
    v_dot2c_f32_bf16_dpp v11, v19, v105 row_newbcast:4 row_mask:0xf bank_mask:0xf
    v_dot2c_f32_bf16_dpp v12, v18, v106 row_newbcast:4 row_mask:0xf bank_mask:0xf
    v_dot2c_f32_bf16_dpp v13, v19, v106 row_newbcast:4 row_mask:0xf bank_mask:0xf
    v_dot2c_f32_bf16_dpp v14, v18, v107 row_newbcast:4 row_mask:0xf bank_mask:0xf
    v_dot2c_f32_bf16_dpp v15, v19, v107 row_newbcast:4 row_mask:0xf bank_mask:0xf
    v_dot2c_f32_bf16_dpp v8, v18, v108 row_newbcast:12 row_mask:0xf bank_mask:0xf
    v_dot2c_f32_bf16_dpp v9, v19, v108 row_newbcast:12 row_mask:0xf bank_mask:0xf
    v_dot2c_f32_bf16_dpp v10, v18, v109 row_newbcast:12 row_mask:0xf bank_mask:0xf
    v_dot2c_f32_bf16_dpp v11, v19, v109 row_newbcast:12 row_mask:0xf bank_mask:0xf
    v_dot2c_f32_bf16_dpp v12, v18, v110 row_newbcast:12 row_mask:0xf bank_mask:0xf
    v_dot2c_f32_bf16_dpp v13, v19, v110 row_newbcast:12 row_mask:0xf bank_mask:0xf
    v_dot2c_f32_bf16_dpp v14, v18, v111 row_newbcast:12 row_mask:0xf bank_mask:0xf
    v_dot2c_f32_bf16_dpp v15, v19, v111 row_newbcast:12 row_mask:0xf bank_mask:0xf
    v_dot2c_f32_bf16_dpp v8, v22, v112 row_newbcast:0 row_mask:0xf bank_mask:0xf
    v_dot2c_f32_bf16_dpp v9, v23, v112 row_newbcast:0 row_mask:0xf bank_mask:0xf
    v_dot2c_f32_bf16_dpp v10, v22, v113 row_newbcast:0 row_mask:0xf bank_mask:0xf
    v_dot2c_f32_bf16_dpp v11, v23, v113 row_newbcast:0 row_mask:0xf bank_mask:0xf
    v_dot2c_f32_bf16_dpp v12, v22, v114 row_newbcast:0 row_mask:0xf bank_mask:0xf
    v_dot2c_f32_bf16_dpp v13, v23, v114 row_newbcast:0 row_mask:0xf bank_mask:0xf
    v_dot2c_f32_bf16_dpp v14, v22, v115 row_newbcast:0 row_mask:0xf bank_mask:0xf
    v_dot2c_f32_bf16_dpp v15, v23, v115 row_newbcast:0 row_mask:0xf bank_mask:0xf
    v_dot2c_f32_bf16_dpp v8, v22, v116 row_newbcast:8 row_mask:0xf bank_mask:0xf
    v_dot2c_f32_bf16_dpp v9, v23, v116 row_newbcast:8 row_mask:0xf bank_mask:0xf
    v_dot2c_f32_bf16_dpp v10, v22, v117 row_newbcast:8 row_mask:0xf bank_mask:0xf
    v_dot2c_f32_bf16_dpp v11, v23, v117 row_newbcast:8 row_mask:0xf bank_mask:0xf
    v_dot2c_f32_bf16_dpp v12, v22, v118 row_newbcast:8 row_mask:0xf bank_mask:0xf
    v_dot2c_f32_bf16_dpp v13, v23, v118 row_newbcast:8 row_mask:0xf bank_mask:0xf
    v_dot2c_f32_bf16_dpp v14, v22, v119 row_newbcast:8 row_mask:0xf bank_mask:0xf
    v_dot2c_f32_bf16_dpp v15, v23, v119 row_newbcast:8 row_mask:0xf bank_mask:0xf
    v_dot2c_f32_bf16_dpp v8, v22, v120 row_newbcast:4 row_mask:0xf bank_mask:0xf
    v_dot2c_f32_bf16_dpp v9, v23, v120 row_newbcast:4 row_mask:0xf bank_mask:0xf
    v_dot2c_f32_bf16_dpp v10, v22, v121 row_newbcast:4 row_mask:0xf bank_mask:0xf
    v_dot2c_f32_bf16_dpp v11, v23, v121 row_newbcast:4 row_mask:0xf bank_mask:0xf
    v_dot2c_f32_bf16_dpp v12, v22, v122 row_newbcast:4 row_mask:0xf bank_mask:0xf
    v_dot2c_f32_bf16_dpp v13, v23, v122 row_newbcast:4 row_mask:0xf bank_mask:0xf
    v_dot2c_f32_bf16_dpp v14, v22, v123 row_newbcast:4 row_mask:0xf bank_mask:0xf
    v_dot2c_f32_bf16_dpp v15, v23, v123 row_newbcast:4 row_mask:0xf bank_mask:0xf
    v_dot2c_f32_bf16_dpp v8, v22, v124 row_newbcast:12 row_mask:0xf bank_mask:0xf
    v_dot2c_f32_bf16_dpp v9, v23, v124 row_newbcast:12 row_mask:0xf bank_mask:0xf
    v_dot2c_f32_bf16_dpp v10, v22, v125 row_newbcast:12 row_mask:0xf bank_mask:0xf
    v_dot2c_f32_bf16_dpp v11, v23, v125 row_newbcast:12 row_mask:0xf bank_mask:0xf
    v_dot2c_f32_bf16_dpp v12, v22, v126 row_newbcast:12 row_mask:0xf bank_mask:0xf
    v_dot2c_f32_bf16_dpp v13, v23, v126 row_newbcast:12 row_mask:0xf bank_mask:0xf
    v_dot2c_f32_bf16_dpp v14, v22, v127 row_newbcast:12 row_mask:0xf bank_mask:0xf
    v_dot2c_f32_bf16_dpp v15, v23, v127 row_newbcast:12 row_mask:0xf bank_mask:0xf
    s_cmp_ge_u32 s42, 2097152
    s_cbranch_scc1 L_sf14
    v_add_u32 v26, s42, v28
    ds_read_b32 v162, v26
    s_branch L_sg14
L_sf14:
    buffer_load_dword v162, v3, s[44:47], s42 offen sc1
L_sg14:
    buffer_load_dwordx4 v[96:99], v2, s[28:31], s76 offen offset:0 nt
    buffer_load_dwordx4 v[100:103], v2, s[28:31], s76 offen offset:512 nt
    buffer_load_dwordx4 v[104:107], v2, s[28:31], s76 offen offset:1024 nt
    buffer_load_dwordx4 v[108:111], v2, s[28:31], s76 offen offset:1536 nt
    buffer_load_dwordx4 v[112:115], v2, s[28:31], s76 offen offset:2048 nt
    buffer_load_dwordx4 v[116:119], v2, s[28:31], s76 offen offset:2560 nt
    buffer_load_dwordx4 v[120:123], v2, s[28:31], s76 offen offset:3072 nt
    buffer_load_dwordx4 v[124:127], v2, s[28:31], s76 offen offset:3584 nt
L_C3:
    s_cmp_eq_u32 s77, 0
    s_cbranch_scc1 L_need1L_hc3
L_hc3:
    s_sub_u32 s77, s77, 1
    s_lshr_b32 s76, s57, 2
    s_lshl_b32 s76, s76, 16
    s_and_b32 s92, s57, 1
    s_lshl_b32 s92, s92, 12
    s_add_u32 s76, s76, s92
    s_and_b32 s92, s57, 2
    s_lshl_b32 s92, s92, 13
    s_add_u32 s76, s76, s92
    s_add_u32 s76, s76, s54
    s_lshr_b32 s42, s57, 1
    s_lshl_b32 s42, s42, 8
    s_lshr_b32 s92, s54, 6
    s_add_u32 s42, s42, s92
    s_and_b32 s92, s57, 1
    s_lshl_b32 s92, s92, 2
    s_and_b32 s92, s92, 4
    s_add_u32 s42, s42, s92
    s_add_u32 s42, s42, s34
    s_add_u32 s57, s57, 1
L_hc3_go:
    s_waitcnt vmcnt(24) lgkmcnt(0)
    v_lshlrev_b32 v20, 16, v163
    v_and_b32 v21, s86, v163
    v_max_f32 v22, v20, v21
    s_nop 1
    v_max_f32_dpp v22, v22, v22 row_ror:8 row_mask:0xf bank_mask:0xf
    s_nop 1
    v_max_f32_dpp v22, v22, v22 row_ror:4 row_mask:0xf bank_mask:0xf
    v_max_f32 v22, v16, v22
    v_sub_f32 v20, v20, v22
    v_sub_f32 v21, v21, v22
    v_sub_f32 v24, v16, v22
    v_mul_f32 v20, s85, v20
    v_mul_f32 v21, s85, v21
    v_mul_f32 v24, s85, v24
    v_exp_f32 v20, v20
    v_exp_f32 v21, v21
    v_exp_f32 v24, v24
    v_mov_b32 v16, v22
    v_cvt_pk_bf16_f32 v18, v20, 0
    v_cvt_pk_bf16_f32 v22, v21, 0
    v_fma_f32 v17, v17, v24, v20
    v_lshlrev_b32 v19, 16, v18
    v_lshlrev_b32 v23, 16, v22
    v_add_f32 v17, v17, v21
    v_pk_mul_f32 v[8:9], v[8:9], v[24:25] op_sel_hi:[1,0]
    v_pk_mul_f32 v[10:11], v[10:11], v[24:25] op_sel_hi:[1,0]
    v_pk_mul_f32 v[12:13], v[12:13], v[24:25] op_sel_hi:[1,0]
    v_pk_mul_f32 v[14:15], v[14:15], v[24:25] op_sel_hi:[1,0]
    v_dot2c_f32_bf16_dpp v8, v18, v128 row_newbcast:0 row_mask:0xf bank_mask:0xf
    v_dot2c_f32_bf16_dpp v9, v19, v128 row_newbcast:0 row_mask:0xf bank_mask:0xf
    v_dot2c_f32_bf16_dpp v10, v18, v129 row_newbcast:0 row_mask:0xf bank_mask:0xf
    v_dot2c_f32_bf16_dpp v11, v19, v129 row_newbcast:0 row_mask:0xf bank_mask:0xf
    v_dot2c_f32_bf16_dpp v12, v18, v130 row_newbcast:0 row_mask:0xf bank_mask:0xf
    v_dot2c_f32_bf16_dpp v13, v19, v130 row_newbcast:0 row_mask:0xf bank_mask:0xf
    v_dot2c_f32_bf16_dpp v14, v18, v131 row_newbcast:0 row_mask:0xf bank_mask:0xf
    v_dot2c_f32_bf16_dpp v15, v19, v131 row_newbcast:0 row_mask:0xf bank_mask:0xf
    v_dot2c_f32_bf16_dpp v8, v18, v132 row_newbcast:8 row_mask:0xf bank_mask:0xf
    v_dot2c_f32_bf16_dpp v9, v19, v132 row_newbcast:8 row_mask:0xf bank_mask:0xf
    v_dot2c_f32_bf16_dpp v10, v18, v133 row_newbcast:8 row_mask:0xf bank_mask:0xf
    v_dot2c_f32_bf16_dpp v11, v19, v133 row_newbcast:8 row_mask:0xf bank_mask:0xf
    v_dot2c_f32_bf16_dpp v12, v18, v134 row_newbcast:8 row_mask:0xf bank_mask:0xf
    v_dot2c_f32_bf16_dpp v13, v19, v134 row_newbcast:8 row_mask:0xf bank_mask:0xf
    v_dot2c_f32_bf16_dpp v14, v18, v135 row_newbcast:8 row_mask:0xf bank_mask:0xf
    v_dot2c_f32_bf16_dpp v15, v19, v135 row_newbcast:8 row_mask:0xf bank_mask:0xf
    v_dot2c_f32_bf16_dpp v8, v18, v136 row_newbcast:4 row_mask:0xf bank_mask:0xf
    v_dot2c_f32_bf16_dpp v9, v19, v136 row_newbcast:4 row_mask:0xf bank_mask:0xf
    v_dot2c_f32_bf16_dpp v10, v18, v137 row_newbcast:4 row_mask:0xf bank_mask:0xf
    v_dot2c_f32_bf16_dpp v11, v19, v137 row_newbcast:4 row_mask:0xf bank_mask:0xf
    v_dot2c_f32_bf16_dpp v12, v18, v138 row_newbcast:4 row_mask:0xf bank_mask:0xf
    v_dot2c_f32_bf16_dpp v13, v19, v138 row_newbcast:4 row_mask:0xf bank_mask:0xf
    v_dot2c_f32_bf16_dpp v14, v18, v139 row_newbcast:4 row_mask:0xf bank_mask:0xf
    v_dot2c_f32_bf16_dpp v15, v19, v139 row_newbcast:4 row_mask:0xf bank_mask:0xf
    v_dot2c_f32_bf16_dpp v8, v18, v140 row_newbcast:12 row_mask:0xf bank_mask:0xf
    v_dot2c_f32_bf16_dpp v9, v19, v140 row_newbcast:12 row_mask:0xf bank_mask:0xf
    v_dot2c_f32_bf16_dpp v10, v18, v141 row_newbcast:12 row_mask:0xf bank_mask:0xf
    v_dot2c_f32_bf16_dpp v11, v19, v141 row_newbcast:12 row_mask:0xf bank_mask:0xf
    v_dot2c_f32_bf16_dpp v12, v18, v142 row_newbcast:12 row_mask:0xf bank_mask:0xf
    v_dot2c_f32_bf16_dpp v13, v19, v142 row_newbcast:12 row_mask:0xf bank_mask:0xf
    v_dot2c_f32_bf16_dpp v14, v18, v143 row_newbcast:12 row_mask:0xf bank_mask:0xf
    v_dot2c_f32_bf16_dpp v15, v19, v143 row_newbcast:12 row_mask:0xf bank_mask:0xf
    v_dot2c_f32_bf16_dpp v8, v22, v144 row_newbcast:0 row_mask:0xf bank_mask:0xf
    v_dot2c_f32_bf16_dpp v9, v23, v144 row_newbcast:0 row_mask:0xf bank_mask:0xf
    v_dot2c_f32_bf16_dpp v10, v22, v145 row_newbcast:0 row_mask:0xf bank_mask:0xf
    v_dot2c_f32_bf16_dpp v11, v23, v145 row_newbcast:0 row_mask:0xf bank_mask:0xf
    v_dot2c_f32_bf16_dpp v12, v22, v146 row_newbcast:0 row_mask:0xf bank_mask:0xf
    v_dot2c_f32_bf16_dpp v13, v23, v146 row_newbcast:0 row_mask:0xf bank_mask:0xf
    v_dot2c_f32_bf16_dpp v14, v22, v147 row_newbcast:0 row_mask:0xf bank_mask:0xf
    v_dot2c_f32_bf16_dpp v15, v23, v147 row_newbcast:0 row_mask:0xf bank_mask:0xf
    v_dot2c_f32_bf16_dpp v8, v22, v148 row_newbcast:8 row_mask:0xf bank_mask:0xf
    v_dot2c_f32_bf16_dpp v9, v23, v148 row_newbcast:8 row_mask:0xf bank_mask:0xf
    v_dot2c_f32_bf16_dpp v10, v22, v149 row_newbcast:8 row_mask:0xf bank_mask:0xf
    v_dot2c_f32_bf16_dpp v11, v23, v149 row_newbcast:8 row_mask:0xf bank_mask:0xf
    v_dot2c_f32_bf16_dpp v12, v22, v150 row_newbcast:8 row_mask:0xf bank_mask:0xf
    v_dot2c_f32_bf16_dpp v13, v23, v150 row_newbcast:8 row_mask:0xf bank_mask:0xf
    v_dot2c_f32_bf16_dpp v14, v22, v151 row_newbcast:8 row_mask:0xf bank_mask:0xf
    v_dot2c_f32_bf16_dpp v15, v23, v151 row_newbcast:8 row_mask:0xf bank_mask:0xf
    v_dot2c_f32_bf16_dpp v8, v22, v152 row_newbcast:4 row_mask:0xf bank_mask:0xf
    v_dot2c_f32_bf16_dpp v9, v23, v152 row_newbcast:4 row_mask:0xf bank_mask:0xf
    v_dot2c_f32_bf16_dpp v10, v22, v153 row_newbcast:4 row_mask:0xf bank_mask:0xf
    v_dot2c_f32_bf16_dpp v11, v23, v153 row_newbcast:4 row_mask:0xf bank_mask:0xf
    v_dot2c_f32_bf16_dpp v12, v22, v154 row_newbcast:4 row_mask:0xf bank_mask:0xf
    v_dot2c_f32_bf16_dpp v13, v23, v154 row_newbcast:4 row_mask:0xf bank_mask:0xf
    v_dot2c_f32_bf16_dpp v14, v22, v155 row_newbcast:4 row_mask:0xf bank_mask:0xf
    v_dot2c_f32_bf16_dpp v15, v23, v155 row_newbcast:4 row_mask:0xf bank_mask:0xf
    v_dot2c_f32_bf16_dpp v8, v22, v156 row_newbcast:12 row_mask:0xf bank_mask:0xf
    v_dot2c_f32_bf16_dpp v9, v23, v156 row_newbcast:12 row_mask:0xf bank_mask:0xf
    v_dot2c_f32_bf16_dpp v10, v22, v157 row_newbcast:12 row_mask:0xf bank_mask:0xf
    v_dot2c_f32_bf16_dpp v11, v23, v157 row_newbcast:12 row_mask:0xf bank_mask:0xf
    v_dot2c_f32_bf16_dpp v12, v22, v158 row_newbcast:12 row_mask:0xf bank_mask:0xf
    v_dot2c_f32_bf16_dpp v13, v23, v158 row_newbcast:12 row_mask:0xf bank_mask:0xf
    v_dot2c_f32_bf16_dpp v14, v22, v159 row_newbcast:12 row_mask:0xf bank_mask:0xf
    v_dot2c_f32_bf16_dpp v15, v23, v159 row_newbcast:12 row_mask:0xf bank_mask:0xf
    s_cmp_ge_u32 s42, 2097152
    s_cbranch_scc1 L_sf15
    v_add_u32 v26, s42, v28
    ds_read_b32 v163, v26
    s_branch L_sg15
L_sf15:
    buffer_load_dword v163, v3, s[44:47], s42 offen sc1
L_sg15:
    buffer_load_dwordx4 v[128:131], v2, s[28:31], s76 offen offset:0 nt
    buffer_load_dwordx4 v[132:135], v2, s[28:31], s76 offen offset:512 nt
    buffer_load_dwordx4 v[136:139], v2, s[28:31], s76 offen offset:1024 nt
    buffer_load_dwordx4 v[140:143], v2, s[28:31], s76 offen offset:1536 nt
    buffer_load_dwordx4 v[144:147], v2, s[28:31], s76 offen offset:2048 nt
    buffer_load_dwordx4 v[148:151], v2, s[28:31], s76 offen offset:2560 nt
    buffer_load_dwordx4 v[152:155], v2, s[28:31], s76 offen offset:3072 nt
    buffer_load_dwordx4 v[156:159], v2, s[28:31], s76 offen offset:3584 nt
    s_branch L_C0
L_need0L_ha0:
    s_cmp_ge_u32 s87, s14
    s_cbranch_scc1 L_dyn0L_ha0
    s_lshr_b32 s76, s51, 2
    s_lshl_b32 s76, s76, 16
    s_and_b32 s92, s51, 1
    s_lshl_b32 s92, s92, 12
    s_add_u32 s76, s76, s92
    s_and_b32 s92, s51, 2
    s_lshl_b32 s92, s92, 13
    s_add_u32 s76, s76, s92
    s_add_u32 s76, s76, s54
    s_add_u32 s51, s51, 4
    s_lshl_b32 s42, s87, 6
    s_add_u32 s42, s42, s35
    s_add_u32 s87, s87, 1
    s_cmp_lt_u32 s87, 24
    s_cselect_b32 s92, 0, 2
    s_sub_u32 s51, s51, s92
    s_cmp_eq_u32 s87, 24
    s_cselect_b32 s51, s17, s51
    s_cmp_lg_u32 s87, s14
    s_cbranch_scc1 L_ha0_go
    v_mov_b32 v26, 7936
    v_mov_b32 v27, 1
    ds_write_b32 v26, v27 offset:8
    s_branch L_ha0_go
L_dyn0L_ha0:
L_early0L_ha0:
    s_sub_u32 s83, s83, 1
    s_cbranch_scc1 L_sw0
    s_mov_b32 s95, 2
    s_lshl_b32 s93, s50, 3
    s_lshl_b32 s90, s95, s93
    s_mov_b32 s91, 0
    s_atomic_add_x2 s[90:91], s[36:37], 0 glc
    s_waitcnt lgkmcnt(0)
    s_cmp_lg_u32 s91, s94
    s_cbranch_scc1 L_early0L_ha0
    s_lshr_b32 s55, s90, s93
    s_and_b32 s55, s55, 0xff
    s_cmp_lt_u32 s55, s15
    s_cbranch_scc1 L_got0L_ha0
    s_cmp_eq_u32 s89, 1
    s_cbranch_scc1 L_sw0
    s_xor_b32 s93, s93, 8
    s_lshr_b32 s55, s90, s93
    s_and_b32 s55, s55, 0xff
    s_cmp_ge_u32 s55, s16
    s_cbranch_scc1 L_sw0
    s_mov_b32 s15, s16
    s_mov_b32 s89, 1
    s_xor_b32 s50, s50, 1
    s_xor_b32 s54, s54, 0x2000
    s_branch L_early0L_ha0
L_got0L_ha0:
    s_sub_u32 s77, s15, s55
    s_sub_u32 s57, 128, s77
    s_min_u32 s77, s77, s95
    s_add_u32 s55, s55, s95
    s_branch L_ha0
L_sw0:
    s_mov_b32 s28, s32
    s_mov_b32 s29, s33
    s_bfe_u32 s50, s48, 0x10001
    s_lshr_b32 s51, s48, 2
    s_lshl_b32 s51, s51, 1
    s_and_b32 s92, s48, 1
    s_add_u32 s51, s51, s92
    s_lshl_b32 s54, s50, 13
    s_mov_b32 s87, 0
    s_mov_b32 s55, 0
    s_cmp_eq_u32 s50, 0
    s_cselect_b32 s15, 24, 24
    s_mov_b32 s89, 0
    s_branch L_B0
L_need1L_hb0:
    s_cmp_ge_u32 s87, s14
    s_cbranch_scc1 L_dyn1L_hb0
    s_lshr_b32 s76, s51, 2
    s_lshl_b32 s76, s76, 16
    s_and_b32 s92, s51, 1
    s_lshl_b32 s92, s92, 12
    s_add_u32 s76, s76, s92
    s_and_b32 s92, s51, 2
    s_lshl_b32 s92, s92, 13
    s_add_u32 s76, s76, s92
    s_add_u32 s76, s76, s54
    s_add_u32 s51, s51, 4
    s_lshl_b32 s42, s87, 6
    s_add_u32 s42, s42, s35
    s_add_u32 s87, s87, 1
    s_cmp_lt_u32 s87, 24
    s_cselect_b32 s92, 0, 2
    s_sub_u32 s51, s51, s92
    s_cmp_eq_u32 s87, 24
    s_cselect_b32 s51, s17, s51
    s_cmp_lg_u32 s87, 9
    s_cbranch_scc1 L_hb0_go
    s_mov_b32 s90, 0x10000
    s_atomic_add s90, s[36:37], 8
    s_branch L_hb0_go
L_dyn1L_hb0:
L_early1L_hb0:
    s_sub_u32 s83, s83, 1
    s_cbranch_scc1 L_never
    s_add_u32 s92, s55, 4
    s_cmp_lt_u32 s92, s15
    s_cselect_b32 s95, 2, 1
    s_lshl_b32 s93, s50, 3
    s_lshl_b32 s90, s95, s93
    s_mov_b32 s91, 0
    s_atomic_add_x2 s[90:91], s[36:37], 8 glc
    s_waitcnt lgkmcnt(0)
    s_cmp_lg_u32 s91, s94
    s_cbranch_scc1 L_early1L_hb0
    s_lshr_b32 s55, s90, s93
    s_and_b32 s55, s55, 0xff
    s_cmp_lt_u32 s55, s15
    s_cbranch_scc1 L_got1L_hb0
    s_cmp_eq_u32 s89, 1
    s_cbranch_scc1 L_never
    s_xor_b32 s93, s93, 8
    s_lshr_b32 s55, s90, s93
    s_and_b32 s55, s55, 0xff
    s_cmp_ge_u32 s55, s16
    s_cbranch_scc1 L_never
    s_mov_b32 s15, s16
    s_mov_b32 s89, 1
    s_xor_b32 s50, s50, 1
    s_xor_b32 s54, s54, 0x2000
    s_branch L_early1L_hb0
L_got1L_hb0:
L_vd1L_hb0:
    s_lshr_b32 s92, s90, 16
    s_cmp_ge_u32 s92, 8
    s_cbranch_scc1 L_vok1L_hb0
    s_sub_u32 s83, s83, 1
    s_cbranch_scc1 L_vok1L_hb0
    s_mov_b32 s90, 0
    s_atomic_add s90, s[36:37], 8 glc
    s_waitcnt lgkmcnt(0)
    s_branch L_vd1L_hb0
L_vok1L_hb0:
    s_sub_u32 s77, s15, s55
    s_sub_u32 s57, 128, s77
    s_min_u32 s77, s77, s95
    s_add_u32 s55, s55, s95
    s_branch L_hb0
L_need1L_hc0:
    s_cmp_ge_u32 s87, s14
    s_cbranch_scc1 L_dyn1L_hc0
    s_lshr_b32 s76, s51, 2
    s_lshl_b32 s76, s76, 16
    s_and_b32 s92, s51, 1
    s_lshl_b32 s92, s92, 12
    s_add_u32 s76, s76, s92
    s_and_b32 s92, s51, 2
    s_lshl_b32 s92, s92, 13
    s_add_u32 s76, s76, s92
    s_add_u32 s76, s76, s54
    s_add_u32 s51, s51, 4
    s_lshl_b32 s42, s87, 6
    s_add_u32 s42, s42, s35
    s_add_u32 s87, s87, 1
    s_cmp_lt_u32 s87, 24
    s_cselect_b32 s92, 0, 2
    s_sub_u32 s51, s51, s92
    s_cmp_eq_u32 s87, 24
    s_cselect_b32 s51, s17, s51
    s_cmp_lg_u32 s87, 9
    s_cbranch_scc1 L_hc0_go
    s_mov_b32 s90, 0x10000
    s_atomic_add s90, s[36:37], 8
    s_branch L_hc0_go
L_dyn1L_hc0:
L_early1L_hc0:
    s_sub_u32 s83, s83, 1
    s_cbranch_scc1 L_dr0
    s_add_u32 s92, s55, 4
    s_cmp_lt_u32 s92, s15
    s_cselect_b32 s95, 2, 1
    s_lshl_b32 s93, s50, 3
    s_lshl_b32 s90, s95, s93
    s_mov_b32 s91, 0
    s_atomic_add_x2 s[90:91], s[36:37], 8 glc
    s_waitcnt lgkmcnt(0)
    s_cmp_lg_u32 s91, s94
    s_cbranch_scc1 L_early1L_hc0
    s_lshr_b32 s55, s90, s93
    s_and_b32 s55, s55, 0xff
    s_cmp_lt_u32 s55, s15
    s_cbranch_scc1 L_got1L_hc0
    s_cmp_eq_u32 s89, 1
    s_cbranch_scc1 L_dr0
    s_xor_b32 s93, s93, 8
    s_lshr_b32 s55, s90, s93
    s_and_b32 s55, s55, 0xff
    s_cmp_ge_u32 s55, s16
    s_cbranch_scc1 L_dr0
    s_mov_b32 s15, s16
    s_mov_b32 s89, 1
    s_xor_b32 s50, s50, 1
    s_xor_b32 s54, s54, 0x2000
    s_branch L_early1L_hc0
L_got1L_hc0:
L_vd1L_hc0:
    s_lshr_b32 s92, s90, 16
    s_cmp_ge_u32 s92, 8
    s_cbranch_scc1 L_vok1L_hc0
    s_sub_u32 s83, s83, 1
    s_cbranch_scc1 L_vok1L_hc0
    s_mov_b32 s90, 0
    s_atomic_add s90, s[36:37], 8 glc
    s_waitcnt lgkmcnt(0)
    s_branch L_vd1L_hc0
L_vok1L_hc0:
    s_sub_u32 s77, s15, s55
    s_sub_u32 s57, 128, s77
    s_min_u32 s77, s77, s95
    s_add_u32 s55, s55, s95
    s_branch L_hc0
L_need0L_ha1:
    s_cmp_ge_u32 s87, s14
    s_cbranch_scc1 L_dyn0L_ha1
    s_lshr_b32 s76, s51, 2
    s_lshl_b32 s76, s76, 16
    s_and_b32 s92, s51, 1
    s_lshl_b32 s92, s92, 12
    s_add_u32 s76, s76, s92
    s_and_b32 s92, s51, 2
    s_lshl_b32 s92, s92, 13
    s_add_u32 s76, s76, s92
    s_add_u32 s76, s76, s54
    s_add_u32 s51, s51, 4
    s_lshl_b32 s42, s87, 6
    s_add_u32 s42, s42, s35
    s_add_u32 s87, s87, 1
    s_cmp_lt_u32 s87, 24
    s_cselect_b32 s92, 0, 2
    s_sub_u32 s51, s51, s92
    s_cmp_eq_u32 s87, 24
    s_cselect_b32 s51, s17, s51
    s_cmp_lg_u32 s87, s14
    s_cbranch_scc1 L_ha1_go
    v_mov_b32 v26, 7936
    v_mov_b32 v27, 1
    ds_write_b32 v26, v27 offset:8
    s_branch L_ha1_go
L_dyn0L_ha1:
L_early0L_ha1:
    s_sub_u32 s83, s83, 1
    s_cbranch_scc1 L_sw1
    s_mov_b32 s95, 2
    s_lshl_b32 s93, s50, 3
    s_lshl_b32 s90, s95, s93
    s_mov_b32 s91, 0
    s_atomic_add_x2 s[90:91], s[36:37], 0 glc
    s_waitcnt lgkmcnt(0)
    s_cmp_lg_u32 s91, s94
    s_cbranch_scc1 L_early0L_ha1
    s_lshr_b32 s55, s90, s93
    s_and_b32 s55, s55, 0xff
    s_cmp_lt_u32 s55, s15
    s_cbranch_scc1 L_got0L_ha1
    s_cmp_eq_u32 s89, 1
    s_cbranch_scc1 L_sw1
    s_xor_b32 s93, s93, 8
    s_lshr_b32 s55, s90, s93
    s_and_b32 s55, s55, 0xff
    s_cmp_ge_u32 s55, s16
    s_cbranch_scc1 L_sw1
    s_mov_b32 s15, s16
    s_mov_b32 s89, 1
    s_xor_b32 s50, s50, 1
    s_xor_b32 s54, s54, 0x2000
    s_branch L_early0L_ha1
L_got0L_ha1:
    s_sub_u32 s77, s15, s55
    s_sub_u32 s57, 128, s77
    s_min_u32 s77, s77, s95
    s_add_u32 s55, s55, s95
    s_branch L_ha1
L_sw1:
    s_mov_b32 s28, s32
    s_mov_b32 s29, s33
    s_bfe_u32 s50, s48, 0x10001
    s_lshr_b32 s51, s48, 2
    s_lshl_b32 s51, s51, 1
    s_and_b32 s92, s48, 1
    s_add_u32 s51, s51, s92
    s_lshl_b32 s54, s50, 13
    s_mov_b32 s87, 0
    s_mov_b32 s55, 0
    s_cmp_eq_u32 s50, 0
    s_cselect_b32 s15, 24, 24
    s_mov_b32 s89, 0
    s_branch L_B1
L_need1L_hb1:
    s_cmp_ge_u32 s87, s14
    s_cbranch_scc1 L_dyn1L_hb1
    s_lshr_b32 s76, s51, 2
    s_lshl_b32 s76, s76, 16
    s_and_b32 s92, s51, 1
    s_lshl_b32 s92, s92, 12
    s_add_u32 s76, s76, s92
    s_and_b32 s92, s51, 2
    s_lshl_b32 s92, s92, 13
    s_add_u32 s76, s76, s92
    s_add_u32 s76, s76, s54
    s_add_u32 s51, s51, 4
    s_lshl_b32 s42, s87, 6
    s_add_u32 s42, s42, s35
    s_add_u32 s87, s87, 1
    s_cmp_lt_u32 s87, 24
    s_cselect_b32 s92, 0, 2
    s_sub_u32 s51, s51, s92
    s_cmp_eq_u32 s87, 24
    s_cselect_b32 s51, s17, s51
    s_cmp_lg_u32 s87, 9
    s_cbranch_scc1 L_hb1_go
    s_mov_b32 s90, 0x10000
    s_atomic_add s90, s[36:37], 8
    s_branch L_hb1_go
L_dyn1L_hb1:
L_early1L_hb1:
    s_sub_u32 s83, s83, 1
    s_cbranch_scc1 L_never
    s_add_u32 s92, s55, 4
    s_cmp_lt_u32 s92, s15
    s_cselect_b32 s95, 2, 1
    s_lshl_b32 s93, s50, 3
    s_lshl_b32 s90, s95, s93
    s_mov_b32 s91, 0
    s_atomic_add_x2 s[90:91], s[36:37], 8 glc
    s_waitcnt lgkmcnt(0)
    s_cmp_lg_u32 s91, s94
    s_cbranch_scc1 L_early1L_hb1
    s_lshr_b32 s55, s90, s93
    s_and_b32 s55, s55, 0xff
    s_cmp_lt_u32 s55, s15
    s_cbranch_scc1 L_got1L_hb1
    s_cmp_eq_u32 s89, 1
    s_cbranch_scc1 L_never
    s_xor_b32 s93, s93, 8
    s_lshr_b32 s55, s90, s93
    s_and_b32 s55, s55, 0xff
    s_cmp_ge_u32 s55, s16
    s_cbranch_scc1 L_never
    s_mov_b32 s15, s16
    s_mov_b32 s89, 1
    s_xor_b32 s50, s50, 1
    s_xor_b32 s54, s54, 0x2000
    s_branch L_early1L_hb1
L_got1L_hb1:
L_vd1L_hb1:
    s_lshr_b32 s92, s90, 16
    s_cmp_ge_u32 s92, 8
    s_cbranch_scc1 L_vok1L_hb1
    s_sub_u32 s83, s83, 1
    s_cbranch_scc1 L_vok1L_hb1
    s_mov_b32 s90, 0
    s_atomic_add s90, s[36:37], 8 glc
    s_waitcnt lgkmcnt(0)
    s_branch L_vd1L_hb1
L_vok1L_hb1:
    s_sub_u32 s77, s15, s55
    s_sub_u32 s57, 128, s77
    s_min_u32 s77, s77, s95
    s_add_u32 s55, s55, s95
    s_branch L_hb1
L_need1L_hc1:
    s_cmp_ge_u32 s87, s14
    s_cbranch_scc1 L_dyn1L_hc1
    s_lshr_b32 s76, s51, 2
    s_lshl_b32 s76, s76, 16
    s_and_b32 s92, s51, 1
    s_lshl_b32 s92, s92, 12
    s_add_u32 s76, s76, s92
    s_and_b32 s92, s51, 2
    s_lshl_b32 s92, s92, 13
    s_add_u32 s76, s76, s92
    s_add_u32 s76, s76, s54
    s_add_u32 s51, s51, 4
    s_lshl_b32 s42, s87, 6
    s_add_u32 s42, s42, s35
    s_add_u32 s87, s87, 1
    s_cmp_lt_u32 s87, 24
    s_cselect_b32 s92, 0, 2
    s_sub_u32 s51, s51, s92
    s_cmp_eq_u32 s87, 24
    s_cselect_b32 s51, s17, s51
    s_cmp_lg_u32 s87, 9
    s_cbranch_scc1 L_hc1_go
    s_mov_b32 s90, 0x10000
    s_atomic_add s90, s[36:37], 8
    s_branch L_hc1_go
L_dyn1L_hc1:
L_early1L_hc1:
    s_sub_u32 s83, s83, 1
    s_cbranch_scc1 L_dr1
    s_add_u32 s92, s55, 4
    s_cmp_lt_u32 s92, s15
    s_cselect_b32 s95, 2, 1
    s_lshl_b32 s93, s50, 3
    s_lshl_b32 s90, s95, s93
    s_mov_b32 s91, 0
    s_atomic_add_x2 s[90:91], s[36:37], 8 glc
    s_waitcnt lgkmcnt(0)
    s_cmp_lg_u32 s91, s94
    s_cbranch_scc1 L_early1L_hc1
    s_lshr_b32 s55, s90, s93
    s_and_b32 s55, s55, 0xff
    s_cmp_lt_u32 s55, s15
    s_cbranch_scc1 L_got1L_hc1
    s_cmp_eq_u32 s89, 1
    s_cbranch_scc1 L_dr1
    s_xor_b32 s93, s93, 8
    s_lshr_b32 s55, s90, s93
    s_and_b32 s55, s55, 0xff
    s_cmp_ge_u32 s55, s16
    s_cbranch_scc1 L_dr1
    s_mov_b32 s15, s16
    s_mov_b32 s89, 1
    s_xor_b32 s50, s50, 1
    s_xor_b32 s54, s54, 0x2000
    s_branch L_early1L_hc1
L_got1L_hc1:
L_vd1L_hc1:
    s_lshr_b32 s92, s90, 16
    s_cmp_ge_u32 s92, 8
    s_cbranch_scc1 L_vok1L_hc1
    s_sub_u32 s83, s83, 1
    s_cbranch_scc1 L_vok1L_hc1
    s_mov_b32 s90, 0
    s_atomic_add s90, s[36:37], 8 glc
    s_waitcnt lgkmcnt(0)
    s_branch L_vd1L_hc1
L_vok1L_hc1:
    s_sub_u32 s77, s15, s55
    s_sub_u32 s57, 128, s77
    s_min_u32 s77, s77, s95
    s_add_u32 s55, s55, s95
    s_branch L_hc1
L_need0L_ha2:
    s_cmp_ge_u32 s87, s14
    s_cbranch_scc1 L_dyn0L_ha2
    s_lshr_b32 s76, s51, 2
    s_lshl_b32 s76, s76, 16
    s_and_b32 s92, s51, 1
    s_lshl_b32 s92, s92, 12
    s_add_u32 s76, s76, s92
    s_and_b32 s92, s51, 2
    s_lshl_b32 s92, s92, 13
    s_add_u32 s76, s76, s92
    s_add_u32 s76, s76, s54
    s_add_u32 s51, s51, 4
    s_lshl_b32 s42, s87, 6
    s_add_u32 s42, s42, s35
    s_add_u32 s87, s87, 1
    s_cmp_lt_u32 s87, 24
    s_cselect_b32 s92, 0, 2
    s_sub_u32 s51, s51, s92
    s_cmp_eq_u32 s87, 24
    s_cselect_b32 s51, s17, s51
    s_cmp_lg_u32 s87, s14
    s_cbranch_scc1 L_ha2_go
    v_mov_b32 v26, 7936
    v_mov_b32 v27, 1
    ds_write_b32 v26, v27 offset:8
    s_branch L_ha2_go
L_dyn0L_ha2:
L_early0L_ha2:
    s_sub_u32 s83, s83, 1
    s_cbranch_scc1 L_sw2
    s_mov_b32 s95, 2
    s_lshl_b32 s93, s50, 3
    s_lshl_b32 s90, s95, s93
    s_mov_b32 s91, 0
    s_atomic_add_x2 s[90:91], s[36:37], 0 glc
    s_waitcnt lgkmcnt(0)
    s_cmp_lg_u32 s91, s94
    s_cbranch_scc1 L_early0L_ha2
    s_lshr_b32 s55, s90, s93
    s_and_b32 s55, s55, 0xff
    s_cmp_lt_u32 s55, s15
    s_cbranch_scc1 L_got0L_ha2
    s_cmp_eq_u32 s89, 1
    s_cbranch_scc1 L_sw2
    s_xor_b32 s93, s93, 8
    s_lshr_b32 s55, s90, s93
    s_and_b32 s55, s55, 0xff
    s_cmp_ge_u32 s55, s16
    s_cbranch_scc1 L_sw2
    s_mov_b32 s15, s16
    s_mov_b32 s89, 1
    s_xor_b32 s50, s50, 1
    s_xor_b32 s54, s54, 0x2000
    s_branch L_early0L_ha2
L_got0L_ha2:
    s_sub_u32 s77, s15, s55
    s_sub_u32 s57, 128, s77
    s_min_u32 s77, s77, s95
    s_add_u32 s55, s55, s95
    s_branch L_ha2
L_sw2:
    s_mov_b32 s28, s32
    s_mov_b32 s29, s33
    s_bfe_u32 s50, s48, 0x10001
    s_lshr_b32 s51, s48, 2
    s_lshl_b32 s51, s51, 1
    s_and_b32 s92, s48, 1
    s_add_u32 s51, s51, s92
    s_lshl_b32 s54, s50, 13
    s_mov_b32 s87, 0
    s_mov_b32 s55, 0
    s_cmp_eq_u32 s50, 0
    s_cselect_b32 s15, 24, 24
    s_mov_b32 s89, 0
    s_branch L_B2
L_need1L_hb2:
    s_cmp_ge_u32 s87, s14
    s_cbranch_scc1 L_dyn1L_hb2
    s_lshr_b32 s76, s51, 2
    s_lshl_b32 s76, s76, 16
    s_and_b32 s92, s51, 1
    s_lshl_b32 s92, s92, 12
    s_add_u32 s76, s76, s92
    s_and_b32 s92, s51, 2
    s_lshl_b32 s92, s92, 13
    s_add_u32 s76, s76, s92
    s_add_u32 s76, s76, s54
    s_add_u32 s51, s51, 4
    s_lshl_b32 s42, s87, 6
    s_add_u32 s42, s42, s35
    s_add_u32 s87, s87, 1
    s_cmp_lt_u32 s87, 24
    s_cselect_b32 s92, 0, 2
    s_sub_u32 s51, s51, s92
    s_cmp_eq_u32 s87, 24
    s_cselect_b32 s51, s17, s51
    s_cmp_lg_u32 s87, 9
    s_cbranch_scc1 L_hb2_go
    s_mov_b32 s90, 0x10000
    s_atomic_add s90, s[36:37], 8
    s_branch L_hb2_go
L_dyn1L_hb2:
L_early1L_hb2:
    s_sub_u32 s83, s83, 1
    s_cbranch_scc1 L_never
    s_add_u32 s92, s55, 4
    s_cmp_lt_u32 s92, s15
    s_cselect_b32 s95, 2, 1
    s_lshl_b32 s93, s50, 3
    s_lshl_b32 s90, s95, s93
    s_mov_b32 s91, 0
    s_atomic_add_x2 s[90:91], s[36:37], 8 glc
    s_waitcnt lgkmcnt(0)
    s_cmp_lg_u32 s91, s94
    s_cbranch_scc1 L_early1L_hb2
    s_lshr_b32 s55, s90, s93
    s_and_b32 s55, s55, 0xff
    s_cmp_lt_u32 s55, s15
    s_cbranch_scc1 L_got1L_hb2
    s_cmp_eq_u32 s89, 1
    s_cbranch_scc1 L_never
    s_xor_b32 s93, s93, 8
    s_lshr_b32 s55, s90, s93
    s_and_b32 s55, s55, 0xff
    s_cmp_ge_u32 s55, s16
    s_cbranch_scc1 L_never
    s_mov_b32 s15, s16
    s_mov_b32 s89, 1
    s_xor_b32 s50, s50, 1
    s_xor_b32 s54, s54, 0x2000
    s_branch L_early1L_hb2
L_got1L_hb2:
L_vd1L_hb2:
    s_lshr_b32 s92, s90, 16
    s_cmp_ge_u32 s92, 8
    s_cbranch_scc1 L_vok1L_hb2
    s_sub_u32 s83, s83, 1
    s_cbranch_scc1 L_vok1L_hb2
    s_mov_b32 s90, 0
    s_atomic_add s90, s[36:37], 8 glc
    s_waitcnt lgkmcnt(0)
    s_branch L_vd1L_hb2
L_vok1L_hb2:
    s_sub_u32 s77, s15, s55
    s_sub_u32 s57, 128, s77
    s_min_u32 s77, s77, s95
    s_add_u32 s55, s55, s95
    s_branch L_hb2
L_need1L_hc2:
    s_cmp_ge_u32 s87, s14
    s_cbranch_scc1 L_dyn1L_hc2
    s_lshr_b32 s76, s51, 2
    s_lshl_b32 s76, s76, 16
    s_and_b32 s92, s51, 1
    s_lshl_b32 s92, s92, 12
    s_add_u32 s76, s76, s92
    s_and_b32 s92, s51, 2
    s_lshl_b32 s92, s92, 13
    s_add_u32 s76, s76, s92
    s_add_u32 s76, s76, s54
    s_add_u32 s51, s51, 4
    s_lshl_b32 s42, s87, 6
    s_add_u32 s42, s42, s35
    s_add_u32 s87, s87, 1
    s_cmp_lt_u32 s87, 24
    s_cselect_b32 s92, 0, 2
    s_sub_u32 s51, s51, s92
    s_cmp_eq_u32 s87, 24
    s_cselect_b32 s51, s17, s51
    s_cmp_lg_u32 s87, 9
    s_cbranch_scc1 L_hc2_go
    s_mov_b32 s90, 0x10000
    s_atomic_add s90, s[36:37], 8
    s_branch L_hc2_go
L_dyn1L_hc2:
L_early1L_hc2:
    s_sub_u32 s83, s83, 1
    s_cbranch_scc1 L_dr2
    s_add_u32 s92, s55, 4
    s_cmp_lt_u32 s92, s15
    s_cselect_b32 s95, 2, 1
    s_lshl_b32 s93, s50, 3
    s_lshl_b32 s90, s95, s93
    s_mov_b32 s91, 0
    s_atomic_add_x2 s[90:91], s[36:37], 8 glc
    s_waitcnt lgkmcnt(0)
    s_cmp_lg_u32 s91, s94
    s_cbranch_scc1 L_early1L_hc2
    s_lshr_b32 s55, s90, s93
    s_and_b32 s55, s55, 0xff
    s_cmp_lt_u32 s55, s15
    s_cbranch_scc1 L_got1L_hc2
    s_cmp_eq_u32 s89, 1
    s_cbranch_scc1 L_dr2
    s_xor_b32 s93, s93, 8
    s_lshr_b32 s55, s90, s93
    s_and_b32 s55, s55, 0xff
    s_cmp_ge_u32 s55, s16
    s_cbranch_scc1 L_dr2
    s_mov_b32 s15, s16
    s_mov_b32 s89, 1
    s_xor_b32 s50, s50, 1
    s_xor_b32 s54, s54, 0x2000
    s_branch L_early1L_hc2
L_got1L_hc2:
L_vd1L_hc2:
    s_lshr_b32 s92, s90, 16
    s_cmp_ge_u32 s92, 8
    s_cbranch_scc1 L_vok1L_hc2
    s_sub_u32 s83, s83, 1
    s_cbranch_scc1 L_vok1L_hc2
    s_mov_b32 s90, 0
    s_atomic_add s90, s[36:37], 8 glc
    s_waitcnt lgkmcnt(0)
    s_branch L_vd1L_hc2
L_vok1L_hc2:
    s_sub_u32 s77, s15, s55
    s_sub_u32 s57, 128, s77
    s_min_u32 s77, s77, s95
    s_add_u32 s55, s55, s95
    s_branch L_hc2
L_need0L_ha3:
    s_cmp_ge_u32 s87, s14
    s_cbranch_scc1 L_dyn0L_ha3
    s_lshr_b32 s76, s51, 2
    s_lshl_b32 s76, s76, 16
    s_and_b32 s92, s51, 1
    s_lshl_b32 s92, s92, 12
    s_add_u32 s76, s76, s92
    s_and_b32 s92, s51, 2
    s_lshl_b32 s92, s92, 13
    s_add_u32 s76, s76, s92
    s_add_u32 s76, s76, s54
    s_add_u32 s51, s51, 4
    s_lshl_b32 s42, s87, 6
    s_add_u32 s42, s42, s35
    s_add_u32 s87, s87, 1
    s_cmp_lt_u32 s87, 24
    s_cselect_b32 s92, 0, 2
    s_sub_u32 s51, s51, s92
    s_cmp_eq_u32 s87, 24
    s_cselect_b32 s51, s17, s51
    s_cmp_lg_u32 s87, s14
    s_cbranch_scc1 L_ha3_go
    v_mov_b32 v26, 7936
    v_mov_b32 v27, 1
    ds_write_b32 v26, v27 offset:8
    s_branch L_ha3_go
L_dyn0L_ha3:
L_early0L_ha3:
    s_sub_u32 s83, s83, 1
    s_cbranch_scc1 L_sw3
    s_mov_b32 s95, 2
    s_lshl_b32 s93, s50, 3
    s_lshl_b32 s90, s95, s93
    s_mov_b32 s91, 0
    s_atomic_add_x2 s[90:91], s[36:37], 0 glc
    s_waitcnt lgkmcnt(0)
    s_cmp_lg_u32 s91, s94
    s_cbranch_scc1 L_early0L_ha3
    s_lshr_b32 s55, s90, s93
    s_and_b32 s55, s55, 0xff
    s_cmp_lt_u32 s55, s15
    s_cbranch_scc1 L_got0L_ha3
    s_cmp_eq_u32 s89, 1
    s_cbranch_scc1 L_sw3
    s_xor_b32 s93, s93, 8
    s_lshr_b32 s55, s90, s93
    s_and_b32 s55, s55, 0xff
    s_cmp_ge_u32 s55, s16
    s_cbranch_scc1 L_sw3
    s_mov_b32 s15, s16
    s_mov_b32 s89, 1
    s_xor_b32 s50, s50, 1
    s_xor_b32 s54, s54, 0x2000
    s_branch L_early0L_ha3
L_got0L_ha3:
    s_sub_u32 s77, s15, s55
    s_sub_u32 s57, 128, s77
    s_min_u32 s77, s77, s95
    s_add_u32 s55, s55, s95
    s_branch L_ha3
L_sw3:
    s_mov_b32 s28, s32
    s_mov_b32 s29, s33
    s_bfe_u32 s50, s48, 0x10001
    s_lshr_b32 s51, s48, 2
    s_lshl_b32 s51, s51, 1
    s_and_b32 s92, s48, 1
    s_add_u32 s51, s51, s92
    s_lshl_b32 s54, s50, 13
    s_mov_b32 s87, 0
    s_mov_b32 s55, 0
    s_cmp_eq_u32 s50, 0
    s_cselect_b32 s15, 24, 24
    s_mov_b32 s89, 0
    s_branch L_B3
L_need1L_hb3:
    s_cmp_ge_u32 s87, s14
    s_cbranch_scc1 L_dyn1L_hb3
    s_lshr_b32 s76, s51, 2
    s_lshl_b32 s76, s76, 16
    s_and_b32 s92, s51, 1
    s_lshl_b32 s92, s92, 12
    s_add_u32 s76, s76, s92
    s_and_b32 s92, s51, 2
    s_lshl_b32 s92, s92, 13
    s_add_u32 s76, s76, s92
    s_add_u32 s76, s76, s54
    s_add_u32 s51, s51, 4
    s_lshl_b32 s42, s87, 6
    s_add_u32 s42, s42, s35
    s_add_u32 s87, s87, 1
    s_cmp_lt_u32 s87, 24
    s_cselect_b32 s92, 0, 2
    s_sub_u32 s51, s51, s92
    s_cmp_eq_u32 s87, 24
    s_cselect_b32 s51, s17, s51
    s_cmp_lg_u32 s87, 9
    s_cbranch_scc1 L_hb3_go
    s_mov_b32 s90, 0x10000
    s_atomic_add s90, s[36:37], 8
    s_branch L_hb3_go
L_dyn1L_hb3:
L_early1L_hb3:
    s_sub_u32 s83, s83, 1
    s_cbranch_scc1 L_never
    s_add_u32 s92, s55, 4
    s_cmp_lt_u32 s92, s15
    s_cselect_b32 s95, 2, 1
    s_lshl_b32 s93, s50, 3
    s_lshl_b32 s90, s95, s93
    s_mov_b32 s91, 0
    s_atomic_add_x2 s[90:91], s[36:37], 8 glc
    s_waitcnt lgkmcnt(0)
    s_cmp_lg_u32 s91, s94
    s_cbranch_scc1 L_early1L_hb3
    s_lshr_b32 s55, s90, s93
    s_and_b32 s55, s55, 0xff
    s_cmp_lt_u32 s55, s15
    s_cbranch_scc1 L_got1L_hb3
    s_cmp_eq_u32 s89, 1
    s_cbranch_scc1 L_never
    s_xor_b32 s93, s93, 8
    s_lshr_b32 s55, s90, s93
    s_and_b32 s55, s55, 0xff
    s_cmp_ge_u32 s55, s16
    s_cbranch_scc1 L_never
    s_mov_b32 s15, s16
    s_mov_b32 s89, 1
    s_xor_b32 s50, s50, 1
    s_xor_b32 s54, s54, 0x2000
    s_branch L_early1L_hb3
L_got1L_hb3:
L_vd1L_hb3:
    s_lshr_b32 s92, s90, 16
    s_cmp_ge_u32 s92, 8
    s_cbranch_scc1 L_vok1L_hb3
    s_sub_u32 s83, s83, 1
    s_cbranch_scc1 L_vok1L_hb3
    s_mov_b32 s90, 0
    s_atomic_add s90, s[36:37], 8 glc
    s_waitcnt lgkmcnt(0)
    s_branch L_vd1L_hb3
L_vok1L_hb3:
    s_sub_u32 s77, s15, s55
    s_sub_u32 s57, 128, s77
    s_min_u32 s77, s77, s95
    s_add_u32 s55, s55, s95
    s_branch L_hb3
L_need1L_hc3:
    s_cmp_ge_u32 s87, s14
    s_cbranch_scc1 L_dyn1L_hc3
    s_lshr_b32 s76, s51, 2
    s_lshl_b32 s76, s76, 16
    s_and_b32 s92, s51, 1
    s_lshl_b32 s92, s92, 12
    s_add_u32 s76, s76, s92
    s_and_b32 s92, s51, 2
    s_lshl_b32 s92, s92, 13
    s_add_u32 s76, s76, s92
    s_add_u32 s76, s76, s54
    s_add_u32 s51, s51, 4
    s_lshl_b32 s42, s87, 6
    s_add_u32 s42, s42, s35
    s_add_u32 s87, s87, 1
    s_cmp_lt_u32 s87, 24
    s_cselect_b32 s92, 0, 2
    s_sub_u32 s51, s51, s92
    s_cmp_eq_u32 s87, 24
    s_cselect_b32 s51, s17, s51
    s_cmp_lg_u32 s87, 9
    s_cbranch_scc1 L_hc3_go
    s_mov_b32 s90, 0x10000
    s_atomic_add s90, s[36:37], 8
    s_branch L_hc3_go
L_dyn1L_hc3:
L_early1L_hc3:
    s_sub_u32 s83, s83, 1
    s_cbranch_scc1 L_dr3
    s_add_u32 s92, s55, 4
    s_cmp_lt_u32 s92, s15
    s_cselect_b32 s95, 2, 1
    s_lshl_b32 s93, s50, 3
    s_lshl_b32 s90, s95, s93
    s_mov_b32 s91, 0
    s_atomic_add_x2 s[90:91], s[36:37], 8 glc
    s_waitcnt lgkmcnt(0)
    s_cmp_lg_u32 s91, s94
    s_cbranch_scc1 L_early1L_hc3
    s_lshr_b32 s55, s90, s93
    s_and_b32 s55, s55, 0xff
    s_cmp_lt_u32 s55, s15
    s_cbranch_scc1 L_got1L_hc3
    s_cmp_eq_u32 s89, 1
    s_cbranch_scc1 L_dr3
    s_xor_b32 s93, s93, 8
    s_lshr_b32 s55, s90, s93
    s_and_b32 s55, s55, 0xff
    s_cmp_ge_u32 s55, s16
    s_cbranch_scc1 L_dr3
    s_mov_b32 s15, s16
    s_mov_b32 s89, 1
    s_xor_b32 s50, s50, 1
    s_xor_b32 s54, s54, 0x2000
    s_branch L_early1L_hc3
L_got1L_hc3:
L_vd1L_hc3:
    s_lshr_b32 s92, s90, 16
    s_cmp_ge_u32 s92, 8
    s_cbranch_scc1 L_vok1L_hc3
    s_sub_u32 s83, s83, 1
    s_cbranch_scc1 L_vok1L_hc3
    s_mov_b32 s90, 0
    s_atomic_add s90, s[36:37], 8 glc
    s_waitcnt lgkmcnt(0)
    s_branch L_vd1L_hc3
L_vok1L_hc3:
    s_sub_u32 s77, s15, s55
    s_sub_u32 s57, 128, s77
    s_min_u32 s77, s77, s95
    s_add_u32 s55, s55, s95
    s_branch L_hc3
L_never:
    s_branch L_sdone
L_dr0:
    s_mov_b32 s88, 4
L_D0:
    s_sub_u32 s88, s88, 1
    s_cmp_lg_u32 s88, 3
    s_cbranch_scc1 L_w4a_3
    s_waitcnt vmcnt(24) lgkmcnt(0)
    s_branch L_w4a
L_w4a_3:
    s_cmp_lg_u32 s88, 2
    s_cbranch_scc1 L_w4a_2
    s_waitcnt vmcnt(16) lgkmcnt(0)
    s_branch L_w4a
L_w4a_2:
    s_cmp_lg_u32 s88, 1
    s_cbranch_scc1 L_w4a_1
    s_waitcnt vmcnt(8) lgkmcnt(0)
    s_branch L_w4a
L_w4a_1:
    s_waitcnt vmcnt(0) lgkmcnt(0)
L_w4a:
    v_lshlrev_b32 v20, 16, v160
    v_and_b32 v21, s86, v160
    v_max_f32 v22, v20, v21
    s_nop 1
    v_max_f32_dpp v22, v22, v22 row_ror:8 row_mask:0xf bank_mask:0xf
    s_nop 1
    v_max_f32_dpp v22, v22, v22 row_ror:4 row_mask:0xf bank_mask:0xf
    v_max_f32 v22, v16, v22
    v_sub_f32 v20, v20, v22
    v_sub_f32 v21, v21, v22
    v_sub_f32 v24, v16, v22
    v_mul_f32 v20, s85, v20
    v_mul_f32 v21, s85, v21
    v_mul_f32 v24, s85, v24
    v_exp_f32 v20, v20
    v_exp_f32 v21, v21
    v_exp_f32 v24, v24
    v_mov_b32 v16, v22
    v_cvt_pk_bf16_f32 v18, v20, 0
    v_cvt_pk_bf16_f32 v22, v21, 0
    v_fma_f32 v17, v17, v24, v20
    v_lshlrev_b32 v19, 16, v18
    v_lshlrev_b32 v23, 16, v22
    v_add_f32 v17, v17, v21
    v_pk_mul_f32 v[8:9], v[8:9], v[24:25] op_sel_hi:[1,0]
    v_pk_mul_f32 v[10:11], v[10:11], v[24:25] op_sel_hi:[1,0]
    v_pk_mul_f32 v[12:13], v[12:13], v[24:25] op_sel_hi:[1,0]
    v_pk_mul_f32 v[14:15], v[14:15], v[24:25] op_sel_hi:[1,0]
    v_dot2c_f32_bf16_dpp v8, v18, v32 row_newbcast:0 row_mask:0xf bank_mask:0xf
    v_dot2c_f32_bf16_dpp v9, v19, v32 row_newbcast:0 row_mask:0xf bank_mask:0xf
    v_dot2c_f32_bf16_dpp v10, v18, v33 row_newbcast:0 row_mask:0xf bank_mask:0xf
    v_dot2c_f32_bf16_dpp v11, v19, v33 row_newbcast:0 row_mask:0xf bank_mask:0xf
    v_dot2c_f32_bf16_dpp v12, v18, v34 row_newbcast:0 row_mask:0xf bank_mask:0xf
    v_dot2c_f32_bf16_dpp v13, v19, v34 row_newbcast:0 row_mask:0xf bank_mask:0xf
    v_dot2c_f32_bf16_dpp v14, v18, v35 row_newbcast:0 row_mask:0xf bank_mask:0xf
    v_dot2c_f32_bf16_dpp v15, v19, v35 row_newbcast:0 row_mask:0xf bank_mask:0xf
    v_dot2c_f32_bf16_dpp v8, v18, v36 row_newbcast:8 row_mask:0xf bank_mask:0xf
    v_dot2c_f32_bf16_dpp v9, v19, v36 row_newbcast:8 row_mask:0xf bank_mask:0xf
    v_dot2c_f32_bf16_dpp v10, v18, v37 row_newbcast:8 row_mask:0xf bank_mask:0xf
    v_dot2c_f32_bf16_dpp v11, v19, v37 row_newbcast:8 row_mask:0xf bank_mask:0xf
    v_dot2c_f32_bf16_dpp v12, v18, v38 row_newbcast:8 row_mask:0xf bank_mask:0xf
    v_dot2c_f32_bf16_dpp v13, v19, v38 row_newbcast:8 row_mask:0xf bank_mask:0xf
    v_dot2c_f32_bf16_dpp v14, v18, v39 row_newbcast:8 row_mask:0xf bank_mask:0xf
    v_dot2c_f32_bf16_dpp v15, v19, v39 row_newbcast:8 row_mask:0xf bank_mask:0xf
    v_dot2c_f32_bf16_dpp v8, v18, v40 row_newbcast:4 row_mask:0xf bank_mask:0xf
    v_dot2c_f32_bf16_dpp v9, v19, v40 row_newbcast:4 row_mask:0xf bank_mask:0xf
    v_dot2c_f32_bf16_dpp v10, v18, v41 row_newbcast:4 row_mask:0xf bank_mask:0xf
    v_dot2c_f32_bf16_dpp v11, v19, v41 row_newbcast:4 row_mask:0xf bank_mask:0xf
    v_dot2c_f32_bf16_dpp v12, v18, v42 row_newbcast:4 row_mask:0xf bank_mask:0xf
    v_dot2c_f32_bf16_dpp v13, v19, v42 row_newbcast:4 row_mask:0xf bank_mask:0xf
    v_dot2c_f32_bf16_dpp v14, v18, v43 row_newbcast:4 row_mask:0xf bank_mask:0xf
    v_dot2c_f32_bf16_dpp v15, v19, v43 row_newbcast:4 row_mask:0xf bank_mask:0xf
    v_dot2c_f32_bf16_dpp v8, v18, v44 row_newbcast:12 row_mask:0xf bank_mask:0xf
    v_dot2c_f32_bf16_dpp v9, v19, v44 row_newbcast:12 row_mask:0xf bank_mask:0xf
    v_dot2c_f32_bf16_dpp v10, v18, v45 row_newbcast:12 row_mask:0xf bank_mask:0xf
    v_dot2c_f32_bf16_dpp v11, v19, v45 row_newbcast:12 row_mask:0xf bank_mask:0xf
    v_dot2c_f32_bf16_dpp v12, v18, v46 row_newbcast:12 row_mask:0xf bank_mask:0xf
    v_dot2c_f32_bf16_dpp v13, v19, v46 row_newbcast:12 row_mask:0xf bank_mask:0xf
    v_dot2c_f32_bf16_dpp v14, v18, v47 row_newbcast:12 row_mask:0xf bank_mask:0xf
    v_dot2c_f32_bf16_dpp v15, v19, v47 row_newbcast:12 row_mask:0xf bank_mask:0xf
    v_dot2c_f32_bf16_dpp v8, v22, v48 row_newbcast:0 row_mask:0xf bank_mask:0xf
    v_dot2c_f32_bf16_dpp v9, v23, v48 row_newbcast:0 row_mask:0xf bank_mask:0xf
    v_dot2c_f32_bf16_dpp v10, v22, v49 row_newbcast:0 row_mask:0xf bank_mask:0xf
    v_dot2c_f32_bf16_dpp v11, v23, v49 row_newbcast:0 row_mask:0xf bank_mask:0xf
    v_dot2c_f32_bf16_dpp v12, v22, v50 row_newbcast:0 row_mask:0xf bank_mask:0xf
    v_dot2c_f32_bf16_dpp v13, v23, v50 row_newbcast:0 row_mask:0xf bank_mask:0xf
    v_dot2c_f32_bf16_dpp v14, v22, v51 row_newbcast:0 row_mask:0xf bank_mask:0xf
    v_dot2c_f32_bf16_dpp v15, v23, v51 row_newbcast:0 row_mask:0xf bank_mask:0xf
    v_dot2c_f32_bf16_dpp v8, v22, v52 row_newbcast:8 row_mask:0xf bank_mask:0xf
    v_dot2c_f32_bf16_dpp v9, v23, v52 row_newbcast:8 row_mask:0xf bank_mask:0xf
    v_dot2c_f32_bf16_dpp v10, v22, v53 row_newbcast:8 row_mask:0xf bank_mask:0xf
    v_dot2c_f32_bf16_dpp v11, v23, v53 row_newbcast:8 row_mask:0xf bank_mask:0xf
    v_dot2c_f32_bf16_dpp v12, v22, v54 row_newbcast:8 row_mask:0xf bank_mask:0xf
    v_dot2c_f32_bf16_dpp v13, v23, v54 row_newbcast:8 row_mask:0xf bank_mask:0xf
    v_dot2c_f32_bf16_dpp v14, v22, v55 row_newbcast:8 row_mask:0xf bank_mask:0xf
    v_dot2c_f32_bf16_dpp v15, v23, v55 row_newbcast:8 row_mask:0xf bank_mask:0xf
    v_dot2c_f32_bf16_dpp v8, v22, v56 row_newbcast:4 row_mask:0xf bank_mask:0xf
    v_dot2c_f32_bf16_dpp v9, v23, v56 row_newbcast:4 row_mask:0xf bank_mask:0xf
    v_dot2c_f32_bf16_dpp v10, v22, v57 row_newbcast:4 row_mask:0xf bank_mask:0xf
    v_dot2c_f32_bf16_dpp v11, v23, v57 row_newbcast:4 row_mask:0xf bank_mask:0xf
    v_dot2c_f32_bf16_dpp v12, v22, v58 row_newbcast:4 row_mask:0xf bank_mask:0xf
    v_dot2c_f32_bf16_dpp v13, v23, v58 row_newbcast:4 row_mask:0xf bank_mask:0xf
    v_dot2c_f32_bf16_dpp v14, v22, v59 row_newbcast:4 row_mask:0xf bank_mask:0xf
    v_dot2c_f32_bf16_dpp v15, v23, v59 row_newbcast:4 row_mask:0xf bank_mask:0xf
    v_dot2c_f32_bf16_dpp v8, v22, v60 row_newbcast:12 row_mask:0xf bank_mask:0xf
    v_dot2c_f32_bf16_dpp v9, v23, v60 row_newbcast:12 row_mask:0xf bank_mask:0xf
    v_dot2c_f32_bf16_dpp v10, v22, v61 row_newbcast:12 row_mask:0xf bank_mask:0xf
    v_dot2c_f32_bf16_dpp v11, v23, v61 row_newbcast:12 row_mask:0xf bank_mask:0xf
    v_dot2c_f32_bf16_dpp v12, v22, v62 row_newbcast:12 row_mask:0xf bank_mask:0xf
    v_dot2c_f32_bf16_dpp v13, v23, v62 row_newbcast:12 row_mask:0xf bank_mask:0xf
    v_dot2c_f32_bf16_dpp v14, v22, v63 row_newbcast:12 row_mask:0xf bank_mask:0xf
    v_dot2c_f32_bf16_dpp v15, v23, v63 row_newbcast:12 row_mask:0xf bank_mask:0xf
    s_cmp_eq_u32 s88, 0
    s_cbranch_scc1 L_sdone
    s_branch L_D1
L_dr1:
    s_mov_b32 s88, 4
L_D1:
    s_sub_u32 s88, s88, 1
    s_cmp_lg_u32 s88, 3
    s_cbranch_scc1 L_w5a_3
    s_waitcnt vmcnt(24) lgkmcnt(0)
    s_branch L_w5a
L_w5a_3:
    s_cmp_lg_u32 s88, 2
    s_cbranch_scc1 L_w5a_2
    s_waitcnt vmcnt(16) lgkmcnt(0)
    s_branch L_w5a
L_w5a_2:
    s_cmp_lg_u32 s88, 1
    s_cbranch_scc1 L_w5a_1
    s_waitcnt vmcnt(8) lgkmcnt(0)
    s_branch L_w5a
L_w5a_1:
    s_waitcnt vmcnt(0) lgkmcnt(0)
L_w5a:
    v_lshlrev_b32 v20, 16, v161
    v_and_b32 v21, s86, v161
    v_max_f32 v22, v20, v21
    s_nop 1
    v_max_f32_dpp v22, v22, v22 row_ror:8 row_mask:0xf bank_mask:0xf
    s_nop 1
    v_max_f32_dpp v22, v22, v22 row_ror:4 row_mask:0xf bank_mask:0xf
    v_max_f32 v22, v16, v22
    v_sub_f32 v20, v20, v22
    v_sub_f32 v21, v21, v22
    v_sub_f32 v24, v16, v22
    v_mul_f32 v20, s85, v20
    v_mul_f32 v21, s85, v21
    v_mul_f32 v24, s85, v24
    v_exp_f32 v20, v20
    v_exp_f32 v21, v21
    v_exp_f32 v24, v24
    v_mov_b32 v16, v22
    v_cvt_pk_bf16_f32 v18, v20, 0
    v_cvt_pk_bf16_f32 v22, v21, 0
    v_fma_f32 v17, v17, v24, v20
    v_lshlrev_b32 v19, 16, v18
    v_lshlrev_b32 v23, 16, v22
    v_add_f32 v17, v17, v21
    v_pk_mul_f32 v[8:9], v[8:9], v[24:25] op_sel_hi:[1,0]
    v_pk_mul_f32 v[10:11], v[10:11], v[24:25] op_sel_hi:[1,0]
    v_pk_mul_f32 v[12:13], v[12:13], v[24:25] op_sel_hi:[1,0]
    v_pk_mul_f32 v[14:15], v[14:15], v[24:25] op_sel_hi:[1,0]
    v_dot2c_f32_bf16_dpp v8, v18, v64 row_newbcast:0 row_mask:0xf bank_mask:0xf
    v_dot2c_f32_bf16_dpp v9, v19, v64 row_newbcast:0 row_mask:0xf bank_mask:0xf
    v_dot2c_f32_bf16_dpp v10, v18, v65 row_newbcast:0 row_mask:0xf bank_mask:0xf
    v_dot2c_f32_bf16_dpp v11, v19, v65 row_newbcast:0 row_mask:0xf bank_mask:0xf
    v_dot2c_f32_bf16_dpp v12, v18, v66 row_newbcast:0 row_mask:0xf bank_mask:0xf
    v_dot2c_f32_bf16_dpp v13, v19, v66 row_newbcast:0 row_mask:0xf bank_mask:0xf
    v_dot2c_f32_bf16_dpp v14, v18, v67 row_newbcast:0 row_mask:0xf bank_mask:0xf
    v_dot2c_f32_bf16_dpp v15, v19, v67 row_newbcast:0 row_mask:0xf bank_mask:0xf
    v_dot2c_f32_bf16_dpp v8, v18, v68 row_newbcast:8 row_mask:0xf bank_mask:0xf
    v_dot2c_f32_bf16_dpp v9, v19, v68 row_newbcast:8 row_mask:0xf bank_mask:0xf
    v_dot2c_f32_bf16_dpp v10, v18, v69 row_newbcast:8 row_mask:0xf bank_mask:0xf
    v_dot2c_f32_bf16_dpp v11, v19, v69 row_newbcast:8 row_mask:0xf bank_mask:0xf
    v_dot2c_f32_bf16_dpp v12, v18, v70 row_newbcast:8 row_mask:0xf bank_mask:0xf
    v_dot2c_f32_bf16_dpp v13, v19, v70 row_newbcast:8 row_mask:0xf bank_mask:0xf
    v_dot2c_f32_bf16_dpp v14, v18, v71 row_newbcast:8 row_mask:0xf bank_mask:0xf
    v_dot2c_f32_bf16_dpp v15, v19, v71 row_newbcast:8 row_mask:0xf bank_mask:0xf
    v_dot2c_f32_bf16_dpp v8, v18, v72 row_newbcast:4 row_mask:0xf bank_mask:0xf
    v_dot2c_f32_bf16_dpp v9, v19, v72 row_newbcast:4 row_mask:0xf bank_mask:0xf
    v_dot2c_f32_bf16_dpp v10, v18, v73 row_newbcast:4 row_mask:0xf bank_mask:0xf
    v_dot2c_f32_bf16_dpp v11, v19, v73 row_newbcast:4 row_mask:0xf bank_mask:0xf
    v_dot2c_f32_bf16_dpp v12, v18, v74 row_newbcast:4 row_mask:0xf bank_mask:0xf
    v_dot2c_f32_bf16_dpp v13, v19, v74 row_newbcast:4 row_mask:0xf bank_mask:0xf
    v_dot2c_f32_bf16_dpp v14, v18, v75 row_newbcast:4 row_mask:0xf bank_mask:0xf
    v_dot2c_f32_bf16_dpp v15, v19, v75 row_newbcast:4 row_mask:0xf bank_mask:0xf
    v_dot2c_f32_bf16_dpp v8, v18, v76 row_newbcast:12 row_mask:0xf bank_mask:0xf
    v_dot2c_f32_bf16_dpp v9, v19, v76 row_newbcast:12 row_mask:0xf bank_mask:0xf
    v_dot2c_f32_bf16_dpp v10, v18, v77 row_newbcast:12 row_mask:0xf bank_mask:0xf
    v_dot2c_f32_bf16_dpp v11, v19, v77 row_newbcast:12 row_mask:0xf bank_mask:0xf
    v_dot2c_f32_bf16_dpp v12, v18, v78 row_newbcast:12 row_mask:0xf bank_mask:0xf
    v_dot2c_f32_bf16_dpp v13, v19, v78 row_newbcast:12 row_mask:0xf bank_mask:0xf
    v_dot2c_f32_bf16_dpp v14, v18, v79 row_newbcast:12 row_mask:0xf bank_mask:0xf
    v_dot2c_f32_bf16_dpp v15, v19, v79 row_newbcast:12 row_mask:0xf bank_mask:0xf
    v_dot2c_f32_bf16_dpp v8, v22, v80 row_newbcast:0 row_mask:0xf bank_mask:0xf
    v_dot2c_f32_bf16_dpp v9, v23, v80 row_newbcast:0 row_mask:0xf bank_mask:0xf
    v_dot2c_f32_bf16_dpp v10, v22, v81 row_newbcast:0 row_mask:0xf bank_mask:0xf
    v_dot2c_f32_bf16_dpp v11, v23, v81 row_newbcast:0 row_mask:0xf bank_mask:0xf
    v_dot2c_f32_bf16_dpp v12, v22, v82 row_newbcast:0 row_mask:0xf bank_mask:0xf
    v_dot2c_f32_bf16_dpp v13, v23, v82 row_newbcast:0 row_mask:0xf bank_mask:0xf
    v_dot2c_f32_bf16_dpp v14, v22, v83 row_newbcast:0 row_mask:0xf bank_mask:0xf
    v_dot2c_f32_bf16_dpp v15, v23, v83 row_newbcast:0 row_mask:0xf bank_mask:0xf
    v_dot2c_f32_bf16_dpp v8, v22, v84 row_newbcast:8 row_mask:0xf bank_mask:0xf
    v_dot2c_f32_bf16_dpp v9, v23, v84 row_newbcast:8 row_mask:0xf bank_mask:0xf
    v_dot2c_f32_bf16_dpp v10, v22, v85 row_newbcast:8 row_mask:0xf bank_mask:0xf
    v_dot2c_f32_bf16_dpp v11, v23, v85 row_newbcast:8 row_mask:0xf bank_mask:0xf
    v_dot2c_f32_bf16_dpp v12, v22, v86 row_newbcast:8 row_mask:0xf bank_mask:0xf
    v_dot2c_f32_bf16_dpp v13, v23, v86 row_newbcast:8 row_mask:0xf bank_mask:0xf
    v_dot2c_f32_bf16_dpp v14, v22, v87 row_newbcast:8 row_mask:0xf bank_mask:0xf
    v_dot2c_f32_bf16_dpp v15, v23, v87 row_newbcast:8 row_mask:0xf bank_mask:0xf
    v_dot2c_f32_bf16_dpp v8, v22, v88 row_newbcast:4 row_mask:0xf bank_mask:0xf
    v_dot2c_f32_bf16_dpp v9, v23, v88 row_newbcast:4 row_mask:0xf bank_mask:0xf
    v_dot2c_f32_bf16_dpp v10, v22, v89 row_newbcast:4 row_mask:0xf bank_mask:0xf
    v_dot2c_f32_bf16_dpp v11, v23, v89 row_newbcast:4 row_mask:0xf bank_mask:0xf
    v_dot2c_f32_bf16_dpp v12, v22, v90 row_newbcast:4 row_mask:0xf bank_mask:0xf
    v_dot2c_f32_bf16_dpp v13, v23, v90 row_newbcast:4 row_mask:0xf bank_mask:0xf
    v_dot2c_f32_bf16_dpp v14, v22, v91 row_newbcast:4 row_mask:0xf bank_mask:0xf
    v_dot2c_f32_bf16_dpp v15, v23, v91 row_newbcast:4 row_mask:0xf bank_mask:0xf
    v_dot2c_f32_bf16_dpp v8, v22, v92 row_newbcast:12 row_mask:0xf bank_mask:0xf
    v_dot2c_f32_bf16_dpp v9, v23, v92 row_newbcast:12 row_mask:0xf bank_mask:0xf
    v_dot2c_f32_bf16_dpp v10, v22, v93 row_newbcast:12 row_mask:0xf bank_mask:0xf
    v_dot2c_f32_bf16_dpp v11, v23, v93 row_newbcast:12 row_mask:0xf bank_mask:0xf
    v_dot2c_f32_bf16_dpp v12, v22, v94 row_newbcast:12 row_mask:0xf bank_mask:0xf
    v_dot2c_f32_bf16_dpp v13, v23, v94 row_newbcast:12 row_mask:0xf bank_mask:0xf
    v_dot2c_f32_bf16_dpp v14, v22, v95 row_newbcast:12 row_mask:0xf bank_mask:0xf
    v_dot2c_f32_bf16_dpp v15, v23, v95 row_newbcast:12 row_mask:0xf bank_mask:0xf
    s_cmp_eq_u32 s88, 0
    s_cbranch_scc1 L_sdone
    s_branch L_D2
L_dr2:
    s_mov_b32 s88, 4
L_D2:
    s_sub_u32 s88, s88, 1
    s_cmp_lg_u32 s88, 3
    s_cbranch_scc1 L_w6a_3
    s_waitcnt vmcnt(24) lgkmcnt(0)
    s_branch L_w6a
L_w6a_3:
    s_cmp_lg_u32 s88, 2
    s_cbranch_scc1 L_w6a_2
    s_waitcnt vmcnt(16) lgkmcnt(0)
    s_branch L_w6a
L_w6a_2:
    s_cmp_lg_u32 s88, 1
    s_cbranch_scc1 L_w6a_1
    s_waitcnt vmcnt(8) lgkmcnt(0)
    s_branch L_w6a
L_w6a_1:
    s_waitcnt vmcnt(0) lgkmcnt(0)
L_w6a:
    v_lshlrev_b32 v20, 16, v162
    v_and_b32 v21, s86, v162
    v_max_f32 v22, v20, v21
    s_nop 1
    v_max_f32_dpp v22, v22, v22 row_ror:8 row_mask:0xf bank_mask:0xf
    s_nop 1
    v_max_f32_dpp v22, v22, v22 row_ror:4 row_mask:0xf bank_mask:0xf
    v_max_f32 v22, v16, v22
    v_sub_f32 v20, v20, v22
    v_sub_f32 v21, v21, v22
    v_sub_f32 v24, v16, v22
    v_mul_f32 v20, s85, v20
    v_mul_f32 v21, s85, v21
    v_mul_f32 v24, s85, v24
    v_exp_f32 v20, v20
    v_exp_f32 v21, v21
    v_exp_f32 v24, v24
    v_mov_b32 v16, v22
    v_cvt_pk_bf16_f32 v18, v20, 0
    v_cvt_pk_bf16_f32 v22, v21, 0
    v_fma_f32 v17, v17, v24, v20
    v_lshlrev_b32 v19, 16, v18
    v_lshlrev_b32 v23, 16, v22
    v_add_f32 v17, v17, v21
    v_pk_mul_f32 v[8:9], v[8:9], v[24:25] op_sel_hi:[1,0]
    v_pk_mul_f32 v[10:11], v[10:11], v[24:25] op_sel_hi:[1,0]
    v_pk_mul_f32 v[12:13], v[12:13], v[24:25] op_sel_hi:[1,0]
    v_pk_mul_f32 v[14:15], v[14:15], v[24:25] op_sel_hi:[1,0]
    v_dot2c_f32_bf16_dpp v8, v18, v96 row_newbcast:0 row_mask:0xf bank_mask:0xf
    v_dot2c_f32_bf16_dpp v9, v19, v96 row_newbcast:0 row_mask:0xf bank_mask:0xf
    v_dot2c_f32_bf16_dpp v10, v18, v97 row_newbcast:0 row_mask:0xf bank_mask:0xf
    v_dot2c_f32_bf16_dpp v11, v19, v97 row_newbcast:0 row_mask:0xf bank_mask:0xf
    v_dot2c_f32_bf16_dpp v12, v18, v98 row_newbcast:0 row_mask:0xf bank_mask:0xf
    v_dot2c_f32_bf16_dpp v13, v19, v98 row_newbcast:0 row_mask:0xf bank_mask:0xf
    v_dot2c_f32_bf16_dpp v14, v18, v99 row_newbcast:0 row_mask:0xf bank_mask:0xf
    v_dot2c_f32_bf16_dpp v15, v19, v99 row_newbcast:0 row_mask:0xf bank_mask:0xf
    v_dot2c_f32_bf16_dpp v8, v18, v100 row_newbcast:8 row_mask:0xf bank_mask:0xf
    v_dot2c_f32_bf16_dpp v9, v19, v100 row_newbcast:8 row_mask:0xf bank_mask:0xf
    v_dot2c_f32_bf16_dpp v10, v18, v101 row_newbcast:8 row_mask:0xf bank_mask:0xf
    v_dot2c_f32_bf16_dpp v11, v19, v101 row_newbcast:8 row_mask:0xf bank_mask:0xf
    v_dot2c_f32_bf16_dpp v12, v18, v102 row_newbcast:8 row_mask:0xf bank_mask:0xf
    v_dot2c_f32_bf16_dpp v13, v19, v102 row_newbcast:8 row_mask:0xf bank_mask:0xf
    v_dot2c_f32_bf16_dpp v14, v18, v103 row_newbcast:8 row_mask:0xf bank_mask:0xf
    v_dot2c_f32_bf16_dpp v15, v19, v103 row_newbcast:8 row_mask:0xf bank_mask:0xf
    v_dot2c_f32_bf16_dpp v8, v18, v104 row_newbcast:4 row_mask:0xf bank_mask:0xf
    v_dot2c_f32_bf16_dpp v9, v19, v104 row_newbcast:4 row_mask:0xf bank_mask:0xf
    v_dot2c_f32_bf16_dpp v10, v18, v105 row_newbcast:4 row_mask:0xf bank_mask:0xf
    v_dot2c_f32_bf16_dpp v11, v19, v105 row_newbcast:4 row_mask:0xf bank_mask:0xf
    v_dot2c_f32_bf16_dpp v12, v18, v106 row_newbcast:4 row_mask:0xf bank_mask:0xf
    v_dot2c_f32_bf16_dpp v13, v19, v106 row_newbcast:4 row_mask:0xf bank_mask:0xf
    v_dot2c_f32_bf16_dpp v14, v18, v107 row_newbcast:4 row_mask:0xf bank_mask:0xf
    v_dot2c_f32_bf16_dpp v15, v19, v107 row_newbcast:4 row_mask:0xf bank_mask:0xf
    v_dot2c_f32_bf16_dpp v8, v18, v108 row_newbcast:12 row_mask:0xf bank_mask:0xf
    v_dot2c_f32_bf16_dpp v9, v19, v108 row_newbcast:12 row_mask:0xf bank_mask:0xf
    v_dot2c_f32_bf16_dpp v10, v18, v109 row_newbcast:12 row_mask:0xf bank_mask:0xf
    v_dot2c_f32_bf16_dpp v11, v19, v109 row_newbcast:12 row_mask:0xf bank_mask:0xf
    v_dot2c_f32_bf16_dpp v12, v18, v110 row_newbcast:12 row_mask:0xf bank_mask:0xf
    v_dot2c_f32_bf16_dpp v13, v19, v110 row_newbcast:12 row_mask:0xf bank_mask:0xf
    v_dot2c_f32_bf16_dpp v14, v18, v111 row_newbcast:12 row_mask:0xf bank_mask:0xf
    v_dot2c_f32_bf16_dpp v15, v19, v111 row_newbcast:12 row_mask:0xf bank_mask:0xf
    v_dot2c_f32_bf16_dpp v8, v22, v112 row_newbcast:0 row_mask:0xf bank_mask:0xf
    v_dot2c_f32_bf16_dpp v9, v23, v112 row_newbcast:0 row_mask:0xf bank_mask:0xf
    v_dot2c_f32_bf16_dpp v10, v22, v113 row_newbcast:0 row_mask:0xf bank_mask:0xf
    v_dot2c_f32_bf16_dpp v11, v23, v113 row_newbcast:0 row_mask:0xf bank_mask:0xf
    v_dot2c_f32_bf16_dpp v12, v22, v114 row_newbcast:0 row_mask:0xf bank_mask:0xf
    v_dot2c_f32_bf16_dpp v13, v23, v114 row_newbcast:0 row_mask:0xf bank_mask:0xf
    v_dot2c_f32_bf16_dpp v14, v22, v115 row_newbcast:0 row_mask:0xf bank_mask:0xf
    v_dot2c_f32_bf16_dpp v15, v23, v115 row_newbcast:0 row_mask:0xf bank_mask:0xf
    v_dot2c_f32_bf16_dpp v8, v22, v116 row_newbcast:8 row_mask:0xf bank_mask:0xf
    v_dot2c_f32_bf16_dpp v9, v23, v116 row_newbcast:8 row_mask:0xf bank_mask:0xf
    v_dot2c_f32_bf16_dpp v10, v22, v117 row_newbcast:8 row_mask:0xf bank_mask:0xf
    v_dot2c_f32_bf16_dpp v11, v23, v117 row_newbcast:8 row_mask:0xf bank_mask:0xf
    v_dot2c_f32_bf16_dpp v12, v22, v118 row_newbcast:8 row_mask:0xf bank_mask:0xf
    v_dot2c_f32_bf16_dpp v13, v23, v118 row_newbcast:8 row_mask:0xf bank_mask:0xf
    v_dot2c_f32_bf16_dpp v14, v22, v119 row_newbcast:8 row_mask:0xf bank_mask:0xf
    v_dot2c_f32_bf16_dpp v15, v23, v119 row_newbcast:8 row_mask:0xf bank_mask:0xf
    v_dot2c_f32_bf16_dpp v8, v22, v120 row_newbcast:4 row_mask:0xf bank_mask:0xf
    v_dot2c_f32_bf16_dpp v9, v23, v120 row_newbcast:4 row_mask:0xf bank_mask:0xf
    v_dot2c_f32_bf16_dpp v10, v22, v121 row_newbcast:4 row_mask:0xf bank_mask:0xf
    v_dot2c_f32_bf16_dpp v11, v23, v121 row_newbcast:4 row_mask:0xf bank_mask:0xf
    v_dot2c_f32_bf16_dpp v12, v22, v122 row_newbcast:4 row_mask:0xf bank_mask:0xf
    v_dot2c_f32_bf16_dpp v13, v23, v122 row_newbcast:4 row_mask:0xf bank_mask:0xf
    v_dot2c_f32_bf16_dpp v14, v22, v123 row_newbcast:4 row_mask:0xf bank_mask:0xf
    v_dot2c_f32_bf16_dpp v15, v23, v123 row_newbcast:4 row_mask:0xf bank_mask:0xf
    v_dot2c_f32_bf16_dpp v8, v22, v124 row_newbcast:12 row_mask:0xf bank_mask:0xf
    v_dot2c_f32_bf16_dpp v9, v23, v124 row_newbcast:12 row_mask:0xf bank_mask:0xf
    v_dot2c_f32_bf16_dpp v10, v22, v125 row_newbcast:12 row_mask:0xf bank_mask:0xf
    v_dot2c_f32_bf16_dpp v11, v23, v125 row_newbcast:12 row_mask:0xf bank_mask:0xf
    v_dot2c_f32_bf16_dpp v12, v22, v126 row_newbcast:12 row_mask:0xf bank_mask:0xf
    v_dot2c_f32_bf16_dpp v13, v23, v126 row_newbcast:12 row_mask:0xf bank_mask:0xf
    v_dot2c_f32_bf16_dpp v14, v22, v127 row_newbcast:12 row_mask:0xf bank_mask:0xf
    v_dot2c_f32_bf16_dpp v15, v23, v127 row_newbcast:12 row_mask:0xf bank_mask:0xf
    s_cmp_eq_u32 s88, 0
    s_cbranch_scc1 L_sdone
    s_branch L_D3
L_dr3:
    s_mov_b32 s88, 4
L_D3:
    s_sub_u32 s88, s88, 1
    s_cmp_lg_u32 s88, 3
    s_cbranch_scc1 L_w7a_3
    s_waitcnt vmcnt(24) lgkmcnt(0)
    s_branch L_w7a
L_w7a_3:
    s_cmp_lg_u32 s88, 2
    s_cbranch_scc1 L_w7a_2
    s_waitcnt vmcnt(16) lgkmcnt(0)
    s_branch L_w7a
L_w7a_2:
    s_cmp_lg_u32 s88, 1
    s_cbranch_scc1 L_w7a_1
    s_waitcnt vmcnt(8) lgkmcnt(0)
    s_branch L_w7a
L_w7a_1:
    s_waitcnt vmcnt(0) lgkmcnt(0)
L_w7a:
    v_lshlrev_b32 v20, 16, v163
    v_and_b32 v21, s86, v163
    v_max_f32 v22, v20, v21
    s_nop 1
    v_max_f32_dpp v22, v22, v22 row_ror:8 row_mask:0xf bank_mask:0xf
    s_nop 1
    v_max_f32_dpp v22, v22, v22 row_ror:4 row_mask:0xf bank_mask:0xf
    v_max_f32 v22, v16, v22
    v_sub_f32 v20, v20, v22
    v_sub_f32 v21, v21, v22
    v_sub_f32 v24, v16, v22
    v_mul_f32 v20, s85, v20
    v_mul_f32 v21, s85, v21
    v_mul_f32 v24, s85, v24
    v_exp_f32 v20, v20
    v_exp_f32 v21, v21
    v_exp_f32 v24, v24
    v_mov_b32 v16, v22
    v_cvt_pk_bf16_f32 v18, v20, 0
    v_cvt_pk_bf16_f32 v22, v21, 0
    v_fma_f32 v17, v17, v24, v20
    v_lshlrev_b32 v19, 16, v18
    v_lshlrev_b32 v23, 16, v22
    v_add_f32 v17, v17, v21
    v_pk_mul_f32 v[8:9], v[8:9], v[24:25] op_sel_hi:[1,0]
    v_pk_mul_f32 v[10:11], v[10:11], v[24:25] op_sel_hi:[1,0]
    v_pk_mul_f32 v[12:13], v[12:13], v[24:25] op_sel_hi:[1,0]
    v_pk_mul_f32 v[14:15], v[14:15], v[24:25] op_sel_hi:[1,0]
    v_dot2c_f32_bf16_dpp v8, v18, v128 row_newbcast:0 row_mask:0xf bank_mask:0xf
    v_dot2c_f32_bf16_dpp v9, v19, v128 row_newbcast:0 row_mask:0xf bank_mask:0xf
    v_dot2c_f32_bf16_dpp v10, v18, v129 row_newbcast:0 row_mask:0xf bank_mask:0xf
    v_dot2c_f32_bf16_dpp v11, v19, v129 row_newbcast:0 row_mask:0xf bank_mask:0xf
    v_dot2c_f32_bf16_dpp v12, v18, v130 row_newbcast:0 row_mask:0xf bank_mask:0xf
    v_dot2c_f32_bf16_dpp v13, v19, v130 row_newbcast:0 row_mask:0xf bank_mask:0xf
    v_dot2c_f32_bf16_dpp v14, v18, v131 row_newbcast:0 row_mask:0xf bank_mask:0xf
    v_dot2c_f32_bf16_dpp v15, v19, v131 row_newbcast:0 row_mask:0xf bank_mask:0xf
    v_dot2c_f32_bf16_dpp v8, v18, v132 row_newbcast:8 row_mask:0xf bank_mask:0xf
    v_dot2c_f32_bf16_dpp v9, v19, v132 row_newbcast:8 row_mask:0xf bank_mask:0xf
    v_dot2c_f32_bf16_dpp v10, v18, v133 row_newbcast:8 row_mask:0xf bank_mask:0xf
    v_dot2c_f32_bf16_dpp v11, v19, v133 row_newbcast:8 row_mask:0xf bank_mask:0xf
    v_dot2c_f32_bf16_dpp v12, v18, v134 row_newbcast:8 row_mask:0xf bank_mask:0xf
    v_dot2c_f32_bf16_dpp v13, v19, v134 row_newbcast:8 row_mask:0xf bank_mask:0xf
    v_dot2c_f32_bf16_dpp v14, v18, v135 row_newbcast:8 row_mask:0xf bank_mask:0xf
    v_dot2c_f32_bf16_dpp v15, v19, v135 row_newbcast:8 row_mask:0xf bank_mask:0xf
    v_dot2c_f32_bf16_dpp v8, v18, v136 row_newbcast:4 row_mask:0xf bank_mask:0xf
    v_dot2c_f32_bf16_dpp v9, v19, v136 row_newbcast:4 row_mask:0xf bank_mask:0xf
    v_dot2c_f32_bf16_dpp v10, v18, v137 row_newbcast:4 row_mask:0xf bank_mask:0xf
    v_dot2c_f32_bf16_dpp v11, v19, v137 row_newbcast:4 row_mask:0xf bank_mask:0xf
    v_dot2c_f32_bf16_dpp v12, v18, v138 row_newbcast:4 row_mask:0xf bank_mask:0xf
    v_dot2c_f32_bf16_dpp v13, v19, v138 row_newbcast:4 row_mask:0xf bank_mask:0xf
    v_dot2c_f32_bf16_dpp v14, v18, v139 row_newbcast:4 row_mask:0xf bank_mask:0xf
    v_dot2c_f32_bf16_dpp v15, v19, v139 row_newbcast:4 row_mask:0xf bank_mask:0xf
    v_dot2c_f32_bf16_dpp v8, v18, v140 row_newbcast:12 row_mask:0xf bank_mask:0xf
    v_dot2c_f32_bf16_dpp v9, v19, v140 row_newbcast:12 row_mask:0xf bank_mask:0xf
    v_dot2c_f32_bf16_dpp v10, v18, v141 row_newbcast:12 row_mask:0xf bank_mask:0xf
    v_dot2c_f32_bf16_dpp v11, v19, v141 row_newbcast:12 row_mask:0xf bank_mask:0xf
    v_dot2c_f32_bf16_dpp v12, v18, v142 row_newbcast:12 row_mask:0xf bank_mask:0xf
    v_dot2c_f32_bf16_dpp v13, v19, v142 row_newbcast:12 row_mask:0xf bank_mask:0xf
    v_dot2c_f32_bf16_dpp v14, v18, v143 row_newbcast:12 row_mask:0xf bank_mask:0xf
    v_dot2c_f32_bf16_dpp v15, v19, v143 row_newbcast:12 row_mask:0xf bank_mask:0xf
    v_dot2c_f32_bf16_dpp v8, v22, v144 row_newbcast:0 row_mask:0xf bank_mask:0xf
    v_dot2c_f32_bf16_dpp v9, v23, v144 row_newbcast:0 row_mask:0xf bank_mask:0xf
    v_dot2c_f32_bf16_dpp v10, v22, v145 row_newbcast:0 row_mask:0xf bank_mask:0xf
    v_dot2c_f32_bf16_dpp v11, v23, v145 row_newbcast:0 row_mask:0xf bank_mask:0xf
    v_dot2c_f32_bf16_dpp v12, v22, v146 row_newbcast:0 row_mask:0xf bank_mask:0xf
    v_dot2c_f32_bf16_dpp v13, v23, v146 row_newbcast:0 row_mask:0xf bank_mask:0xf
    v_dot2c_f32_bf16_dpp v14, v22, v147 row_newbcast:0 row_mask:0xf bank_mask:0xf
    v_dot2c_f32_bf16_dpp v15, v23, v147 row_newbcast:0 row_mask:0xf bank_mask:0xf
    v_dot2c_f32_bf16_dpp v8, v22, v148 row_newbcast:8 row_mask:0xf bank_mask:0xf
    v_dot2c_f32_bf16_dpp v9, v23, v148 row_newbcast:8 row_mask:0xf bank_mask:0xf
    v_dot2c_f32_bf16_dpp v10, v22, v149 row_newbcast:8 row_mask:0xf bank_mask:0xf
    v_dot2c_f32_bf16_dpp v11, v23, v149 row_newbcast:8 row_mask:0xf bank_mask:0xf
    v_dot2c_f32_bf16_dpp v12, v22, v150 row_newbcast:8 row_mask:0xf bank_mask:0xf
    v_dot2c_f32_bf16_dpp v13, v23, v150 row_newbcast:8 row_mask:0xf bank_mask:0xf
    v_dot2c_f32_bf16_dpp v14, v22, v151 row_newbcast:8 row_mask:0xf bank_mask:0xf
    v_dot2c_f32_bf16_dpp v15, v23, v151 row_newbcast:8 row_mask:0xf bank_mask:0xf
    v_dot2c_f32_bf16_dpp v8, v22, v152 row_newbcast:4 row_mask:0xf bank_mask:0xf
    v_dot2c_f32_bf16_dpp v9, v23, v152 row_newbcast:4 row_mask:0xf bank_mask:0xf
    v_dot2c_f32_bf16_dpp v10, v22, v153 row_newbcast:4 row_mask:0xf bank_mask:0xf
    v_dot2c_f32_bf16_dpp v11, v23, v153 row_newbcast:4 row_mask:0xf bank_mask:0xf
    v_dot2c_f32_bf16_dpp v12, v22, v154 row_newbcast:4 row_mask:0xf bank_mask:0xf
    v_dot2c_f32_bf16_dpp v13, v23, v154 row_newbcast:4 row_mask:0xf bank_mask:0xf
    v_dot2c_f32_bf16_dpp v14, v22, v155 row_newbcast:4 row_mask:0xf bank_mask:0xf
    v_dot2c_f32_bf16_dpp v15, v23, v155 row_newbcast:4 row_mask:0xf bank_mask:0xf
    v_dot2c_f32_bf16_dpp v8, v22, v156 row_newbcast:12 row_mask:0xf bank_mask:0xf
    v_dot2c_f32_bf16_dpp v9, v23, v156 row_newbcast:12 row_mask:0xf bank_mask:0xf
    v_dot2c_f32_bf16_dpp v10, v22, v157 row_newbcast:12 row_mask:0xf bank_mask:0xf
    v_dot2c_f32_bf16_dpp v11, v23, v157 row_newbcast:12 row_mask:0xf bank_mask:0xf
    v_dot2c_f32_bf16_dpp v12, v22, v158 row_newbcast:12 row_mask:0xf bank_mask:0xf
    v_dot2c_f32_bf16_dpp v13, v23, v158 row_newbcast:12 row_mask:0xf bank_mask:0xf
    v_dot2c_f32_bf16_dpp v14, v22, v159 row_newbcast:12 row_mask:0xf bank_mask:0xf
    v_dot2c_f32_bf16_dpp v15, v23, v159 row_newbcast:12 row_mask:0xf bank_mask:0xf
    s_cmp_eq_u32 s88, 0
    s_cbranch_scc1 L_sdone
    s_branch L_D0
L_sdone:
    v_mov_b32 v18, v16
    v_mov_b32 v19, v16
    s_lshl_b32 s78, s2, 11
    s_lshl_b32 s79, s56, 9
    v_permlane16_swap_b32 v18, v19
    s_add_u32 s78, s78, s79
    v_max_f32 v18, v18, v19
    v_mov_b32 v19, v18
    s_add_u32 s78, s78, 131072
    s_lshl_b32 s79, s2, 9
    v_permlane32_swap_b32 v18, v19
    s_lshl_b32 s80, s56, 7
    v_max_f32 v18, v18, v19
    v_sub_f32 v20, v16, v18
    v_mul_f32 v20, s85, v20
    v_exp_f32 v20, v20
    s_add_u32 s79, s79, s80
    v_mul_f32 v17, v17, v20
    v_mul_f32 v8, v20, v8
    v_mul_f32 v9, v20, v9
    v_mul_f32 v10, v20, v10
    v_mul_f32 v11, v20, v11
    v_mul_f32 v12, v20, v12
    v_mul_f32 v13, v20, v13
    v_mul_f32 v14, v20, v14
    v_mul_f32 v15, v20, v15
    v_add_f32_dpp v17, v17, v17 row_ror:8 row_mask:0xf bank_mask:0xf
    s_add_u32 s79, s79, 1179648
    v_permlane32_swap_b32 v8, v12
    v_permlane32_swap_b32 v9, v13
    v_add_f32_dpp v17, v17, v17 row_ror:4 row_mask:0xf bank_mask:0xf
    v_permlane32_swap_b32 v10, v14
    v_permlane32_swap_b32 v11, v15
    v_mov_b32 v19, v17
    v_add_f32 v8, v8, v12
    v_add_f32 v9, v9, v13
    v_add_f32 v10, v10, v14
    v_add_f32 v11, v11, v15
    v_permlane16_swap_b32 v17, v19
    v_add_u32 v20, s94, v0
    v_permlane16_swap_b32 v8, v10
    v_permlane16_swap_b32 v9, v11
    v_add_f32 v17, v17, v19
    v_add_f32 v8, v8, v10
    v_mov_b32 v19, v17
    v_add_f32 v9, v9, v11
    s_movk_i32 s80, 0xff
    v_permlane32_swap_b32 v17, v19
    v_lshlrev_b32 v22, 3, v0
    v_add_u32 v21, 64, v20
    v_bfi_b32 v8, s80, v20, v8
    v_bfi_b32 v9, s80, v21, v9
    v_add_f32 v19, v17, v19
    buffer_store_dwordx2 v[8:9], v22, s[44:47], s78 offen sc1
    v_mov_b32 v20, s94
    v_mov_b32 v21, s94
    s_mov_b64 exec, 255
    buffer_store_dwordx4 v[18:21], v1, s[44:47], s79 offen sc1
    s_mov_b64 exec, -1
    s_barrier
    s_cmp_ge_u32 s3, 2
    s_cbranch_scc1 L_bar_done
    s_cmp_eq_u32 s3, 0
    s_cbranch_scc1 L_red
    s_cmp_eq_u32 s98, 0
    s_cbranch_scc1 L_bar_done
    s_mov_b32 s53, 8
L_red:
    s_bfe_u32 s78, s52, 0x20001
    s_mul_i32 s78, s78, 1152
    s_lshr_b32 s79, s52, 3
    s_lshl_b32 s79, s79, 5
    s_add_u32 s78, s78, s79
    s_and_b32 s79, s52, 1
    s_lshl_b32 s79, s79, 4
    s_add_u32 s78, s78, s79
    s_lshl_b32 s79, s53, 7
    s_add_u32 s78, s78, s79
    v_and_b32 v9, 1, v0
    v_lshlrev_b32 v10, 3, v9
    s_mov_b32 s28, s4
    s_mov_b32 s29, s5
    s_mov_b32 s30, 4608
    s_mov_b32 s31, 0x20000
    buffer_load_dwordx2 v[16:17], v10, s[28:31], s78 offen
    s_mov_b32 s40, s22
    s_mov_b32 s41, s23
    s_mov_b32 s42, 4608
    s_mov_b32 s43, 0x20000
    v_lshrrev_b32 v8, 1, v0
    v_lshlrev_b32 v8, 10, v8
    v_lshl_add_u32 v8, v9, 4, v8
    s_lshl_b32 s79, s53, 15
    s_lshl_b32 s80, s52, 5
    s_add_u32 s79, s79, s80
    s_add_u32 s79, s79, 720896
    s_lshl_b32 s80, s52, 3
    s_add_u32 s80, s80, s94
    v_lshl_add_u32 v24, v9, 2, s80
    v_add_u32 v25, 1, v24
    v_add_u32 v26, 2, v24
    v_add_u32 v27, 3, v24
    s_mov_b32 s83, 1048576
    s_barrier
L_h2:
    buffer_load_dwordx4 v[12:15], v8, s[44:47], s79 offen sc1
    s_sub_u32 s83, s83, 1
    s_cbranch_scc1 L_h2_done
    s_waitcnt vmcnt(0)
    v_xor_b32 v20, v24, v12
    v_bitop3_b32 v20, v20, v13, v25 bitop3:0xf6
    v_bitop3_b32 v20, v20, v14, v26 bitop3:0xf6
    v_bitop3_b32 v20, v20, v15, v27 bitop3:0xf6
    v_and_b32 v20, 0xff, v20
    s_nop 1
    v_or_b32_dpp v20, v20, v20 quad_perm:[1,0,3,2] row_mask:0xf bank_mask:0xf
    v_cmp_ne_u32 vcc, 0, v20
    s_and_b64 exec, exec, vcc
    s_cbranch_execnz L_h2
L_h2_done:
    s_mov_b64 exec, -1
    s_waitcnt vmcnt(0)
    s_add_u32 s79, s2, s3
    s_cmp_lg_u32 s79, 0
    s_cbranch_scc1 L_noe
    v_mov_b32 v24, s94
    v_mov_b32 v25, 6291456
    s_mov_b64 exec, 1
    buffer_store_dword v24, v25, s[44:47], 0 offen
    s_mov_b64 exec, -1
L_noe:
    s_movk_i32 s84, 0xff00
    v_and_b32 v12, s84, v12
    v_and_b32 v13, s84, v13
    v_and_b32 v14, s84, v14
    v_and_b32 v15, s84, v15
    v_add_f32_dpp v12, v12, v12 quad_perm:[2,3,0,1] row_mask:0xf bank_mask:0xf
    v_add_f32_dpp v13, v13, v13 quad_perm:[2,3,0,1] row_mask:0xf bank_mask:0xf
    v_add_f32_dpp v14, v14, v14 quad_perm:[2,3,0,1] row_mask:0xf bank_mask:0xf
    v_add_f32_dpp v15, v15, v15 quad_perm:[2,3,0,1] row_mask:0xf bank_mask:0xf
    v_add_f32_dpp v12, v12, v12 row_ror:4 row_mask:0xf bank_mask:0xf
    v_add_f32_dpp v13, v13, v13 row_ror:4 row_mask:0xf bank_mask:0xf
    v_add_f32_dpp v14, v14, v14 row_ror:4 row_mask:0xf bank_mask:0xf
    v_add_f32_dpp v15, v15, v15 row_ror:4 row_mask:0xf bank_mask:0xf
    v_add_f32_dpp v12, v12, v12 row_ror:8 row_mask:0xf bank_mask:0xf
    v_add_f32_dpp v13, v13, v13 row_ror:8 row_mask:0xf bank_mask:0xf
    v_add_f32_dpp v14, v14, v14 row_ror:8 row_mask:0xf bank_mask:0xf
    v_add_f32_dpp v15, v15, v15 row_ror:8 row_mask:0xf bank_mask:0xf
    v_mov_b32 v20, v12
    v_mov_b32 v21, v13
    v_mov_b32 v22, v14
    v_mov_b32 v23, v15
    v_permlane16_swap_b32 v12, v20
    v_permlane16_swap_b32 v13, v21
    v_permlane16_swap_b32 v14, v22
    v_permlane16_swap_b32 v15, v23
    v_add_f32 v12, v12, v20
    v_add_f32 v13, v13, v21
    v_add_f32 v14, v14, v22
    v_add_f32 v15, v15, v23
    v_mov_b32 v20, v12
    v_mov_b32 v21, v13
    v_mov_b32 v22, v14
    v_mov_b32 v23, v15
    v_permlane32_swap_b32 v12, v20
    v_permlane32_swap_b32 v13, v21
    v_permlane32_swap_b32 v14, v22
    v_permlane32_swap_b32 v15, v23
    v_add_f32 v12, v12, v20
    v_add_f32 v13, v13, v21
    v_add_f32 v14, v14, v22
    v_add_f32 v15, v15, v23
    v_lshlrev_b32 v20, 16, v16
    v_and_b32 v21, 0xffff0000, v16
    v_lshlrev_b32 v22, 16, v17
    v_and_b32 v23, 0xffff0000, v17
    v_add_f32 v12, v12, v20
    v_add_f32 v13, v13, v21
    v_add_f32 v14, v14, v22
    v_add_f32 v15, v15, v23
    v_cvt_pk_bf16_f32 v12, v12, v13
    v_cvt_pk_bf16_f32 v13, v14, v15
    s_mov_b64 exec, 3
    buffer_store_dwordx2 v[12:13], v10, s[40:43], s78 offen
    s_branch L_done
L_bar_done:
    s_barrier
    s_branch L_done
.section .rodata,"a"
.p2align 6
.amdhsa_kernel parallel_sum__mha_block_cached__geglu_ffn__decode_kernel
.amdhsa_next_free_vgpr 164
.amdhsa_next_free_sgpr 100
.amdhsa_accum_offset 164
.amdhsa_group_segment_fixed_size 0
.amdhsa_kernarg_size 96
.amdhsa_user_sgpr_count 2
.amdhsa_user_sgpr_kernarg_segment_ptr 1
.amdhsa_system_sgpr_workgroup_id_x 1
.amdhsa_float_denorm_mode_32 3
.end_amdhsa_kernel
```
